```python
import torch

def _softmax(x, axis=-1):
    return torch.softmax(x, dim=axis)
def _gelu(x):
    return torch.nn.functional.gelu(x, approximate="tanh")
def _silu(x):
    return torch.nn.functional.silu(x)
def _sigmoid(x):
    return torch.sigmoid(x)
def _layernorm(x, axis=-1, eps=1e-5):
    m = x.mean(dim=axis, keepdim=True)
    v = x.var(dim=axis, keepdim=True, unbiased=False)
    return (x - m) / torch.sqrt(v + eps)
def _scatter_add(tgt, idx, src, axis=0):
    return tgt.clone().index_add_(axis, idx, src)
def _segment_sum(src, seg, n):
    out = torch.zeros((n,) + src.shape[1:], dtype=src.dtype)
    return out.index_add_(0, seg, src)
def _pad(x, pw):
    flat = tuple(v for pair in reversed(pw) for v in pair)
    return torch.nn.functional.pad(x, flat)

kernel_name = 'parallel_sum__gqa_block_cached__dense_activation_silu__decode'

def setup_inputs():

    _w = (lambda a: (lambda t: t.to(torch.bfloat16) if t.is_floating_point() else t)(torch.as_tensor(a)))
    def _A_setup():
        B, Sq, D = 1, 1, 576
        Hq, Hkv, Sk, Dh = 32, 16, 65536, 128
        assert Hq % Hkv == 0, (Hq, Hkv)
        return {
            "x": _w((lambda *s: torch.randn(*s, dtype=torch.bfloat16) * 0.05)(B, Sq, D)),
            "k_cache": _w((lambda *s: torch.randn(*s, dtype=torch.bfloat16) * 3.2)(B, Hkv, Sk, Dh)),
            "v_cache": _w((lambda *s: torch.randn(*s, dtype=torch.bfloat16) * 0.8)(B, Hkv, Sk, Dh)),
            "wq": _w((lambda *s: torch.randn(*s, dtype=torch.bfloat16) * 3.2)(D, Hq * Dh) * (D ** -0.5)),
            "wo": _w((lambda *s: torch.randn(*s, dtype=torch.bfloat16) * 0.8)(Hq * Dh, D) * ((Hq * Dh) ** -0.5)),
        }
    _A_in = _A_setup()

    def _B_setup():
        B, S, D, F = 1, 1, 576, 4608
        return {
            "x": _w((lambda *s: torch.randn(*s, dtype=torch.bfloat16) * 0.05)(B, S, D)),
            "w1": _w((lambda *s: torch.randn(*s, dtype=torch.bfloat16) * 3.2)(D, F) * (D ** -0.5)),
            "w2": _w((lambda *s: torch.randn(*s, dtype=torch.bfloat16) * 0.4)(F, D) * (F ** -0.5)),
        }
    _B_in = _B_setup()

    return {
        "A_x": _A_in["x"],
        "A_k_cache": _A_in["k_cache"],
        "A_v_cache": _A_in["v_cache"],
        "A_wq": _A_in["wq"],
        "A_wo": _A_in["wo"],
        "B_x": _B_in["x"],
        "B_w1": _B_in["w1"],
        "B_w2": _B_in["w2"],
    }

def reference(A_x, A_k_cache, A_v_cache, A_wq, A_wo, B_x, B_w1, B_w2):
    def _A_ref(x, k_cache, v_cache, wq, wo):
        B, Sq, D = x.shape
        Hq, Dh = 32, 128
        Hkv = k_cache.shape[1]
        rep = Hq // Hkv
        q = (lambda x, *d: x.permute(*d))((x @ wq).reshape(B, Sq, Hq, Dh), 0, 2, 1, 3)
        k = (lambda x, n, axis: torch.repeat_interleave(x, n, dim=axis))(k_cache, rep, axis=1)
        v = (lambda x, n, axis: torch.repeat_interleave(x, n, dim=axis))(v_cache, rep, axis=1)
        scores = torch.einsum("bhqd,bhkd->bhqk", q, k) * (Dh ** -0.5)
        p = _softmax(scores, axis=-1)
        o = torch.einsum("bhqk,bhkd->bhqd", p, v)
        return (lambda x, *d: x.permute(*d))(o, 0, 2, 1, 3).reshape(B, Sq, Hq * Dh) @ wo

    def _B_ref(x, w1, w2):
        h = torch.einsum("bsd,df->bsf", x, w1)
        h = _silu(h)
        out = torch.einsum("bsf,fd->bsd", h, w2)
        return out

    x = A_x
    xn = _layernorm(x, axis=-1)
    return x + _A_ref(xn, A_k_cache, A_v_cache, A_wq, A_wo) + _B_ref(xn, B_w1, B_w2)
```

```asm
; @launch grid=(256,1,1) block=(512,1,1) lds=143360
.amdgcn_target "amdgcn-amd-amdhsa--gfx950"
.text
.globl parallel_sum__gqa_block_cached__dense_activation_silu__decode_kernel
.p2align 8
.type parallel_sum__gqa_block_cached__dense_activation_silu__decode_kernel,@function
parallel_sum__gqa_block_cached__dense_activation_silu__decode_kernel:
  s_cmp_ge_u32 s2, 256
  s_cbranch_scc1 L_end
  s_load_dwordx16 s[4:19], s[0:1], 0
  s_load_dwordx2 s[20:21], s[0:1], 64
  s_load_dwordx2 s[22:23], s[0:1], 80
  v_lshrrev_b32 v1, 6, v0
  v_and_b32 v0, 63, v0
  v_readfirstlane_b32 s3, v1
  s_lshr_b32 s25, s2, 4
  s_and_b32 s26, s2, 15
  s_cmp_ge_u32 s3, 4
  s_cbranch_scc1 L_helper
  s_cmp_ge_u32 s3, 2
  s_cbranch_scc0 L_consumer
  s_sub_u32 s42, s3, 2
  v_and_b32 v14, 7, v0
  v_mul_u32_u24 v2, 256, v14
  v_bfe_u32 v14, v0, 3, 1
  v_lshl_add_u32 v2, v14, 6, v2
  v_lshrrev_b32 v15, 4, v0
  v_lshl_add_u32 v2, v15, 4, v2
  v_add_u32 v3, 4096, v2
  v_mul_u32_u24 v4, 256, v15
  v_and_b32 v14, 15, v0
  v_lshl_add_u32 v4, v14, 4, v4
  v_add_u32 v5, 4096, v4
  s_mul_i32 s51, s26, 2
  s_add_u32 s51, s51, s42
  s_mul_i32 s40, s51, 8192
  s_and_b32 s40, s40, 16777215
  s_mul_i32 s50, s42, 65536
  s_lshl_b32 s53, s25, 24
  s_mov_b32 s52, s50
  s_mov_b32 s49, 0
  s_mov_b32 s48, 0
  s_mov_b32 s41, 0
  s_lshr_b32 s47, s26, 4
  s_mul_i32 s47, s47, 160
  s_add_u32 s47, s47, 1888
  s_waitcnt lgkmcnt(0)
  s_add_u32 s32, s6, s53
  s_addc_u32 s33, s7, 0
  s_and_b32 s33, s33, 0xffff
  s_mov_b32 s34, 16777216
  s_mov_b32 s35, 0x20000
  s_add_u32 s36, s8, s53
  s_addc_u32 s37, s9, 0
  s_and_b32 s37, s37, 0xffff
  s_mov_b32 s38, 16777216
  s_mov_b32 s39, 0x20000
  s_add_u32 m0, s52, 0
  s_nop 0
  buffer_load_dwordx4 v2, s[32:35], s40 offen offset:0 nt lds
  s_add_u32 m0, s52, 896
  s_nop 0
  buffer_load_dwordx4 v2, s[32:35], s40 offen offset:128 nt lds
  s_add_u32 m0, s52, 0
  s_nop 0
  buffer_load_dwordx4 v2, s[32:35], s40 offen offset:2048 nt lds
  s_add_u32 m0, s52, 896
  s_nop 0
  buffer_load_dwordx4 v2, s[32:35], s40 offen offset:2176 nt lds
  s_add_u32 m0, s52, 4096
  s_nop 0
  buffer_load_dwordx4 v3, s[32:35], s40 offen offset:0 nt lds
  s_add_u32 m0, s52, 4992
  s_nop 0
  buffer_load_dwordx4 v3, s[32:35], s40 offen offset:128 nt lds
  s_add_u32 m0, s52, 4096
  s_nop 0
  buffer_load_dwordx4 v3, s[32:35], s40 offen offset:2048 nt lds
  s_add_u32 m0, s52, 4992
  s_nop 0
  buffer_load_dwordx4 v3, s[32:35], s40 offen offset:2176 nt lds
  s_add_u32 m0, s52, 8192
  s_nop 0
  buffer_load_dwordx4 v4, s[36:39], s40 offen offset:0 nt lds
  s_add_u32 m0, s52, 8192
  s_nop 0
  buffer_load_dwordx4 v4, s[36:39], s40 offen offset:1024 nt lds
  s_add_u32 m0, s52, 8192
  s_nop 0
  buffer_load_dwordx4 v4, s[36:39], s40 offen offset:2048 nt lds
  s_load_dword s24, s[22:23], 0
  s_mov_b32 s28, s22
  s_and_b32 s29, s23, 0xffff
  s_mov_b32 s30, 7340032
  s_mov_b32 s31, 0x20000
  s_lshl_b32 s53, s42, 3
  s_add_u32 s54, s53, 133216
  v_mov_b32 v6, s54
  s_add_u32 s54, s53, 133232
  v_mov_b32 v7, s54
  s_lshl_b32 s53, s42, 2
  s_add_u32 s53, s53, 133136
  v_mov_b32 v8, s53
  s_lshl_b32 s53, s42, 4
  s_add_u32 s53, s53, 133152
  v_mov_b32 v9, s53
  v_mov_b32 v12, 0
  s_mov_b32 s43, 0xfffffff9
  s_mov_b32 s44, 8
  s_mov_b32 s45, 4
  s_mov_b32 s46, 0
  s_getpc_b64 s[58:59]
L_pcl:
  s_add_u32 s58, s58, L_ld_full-L_pcl
  s_addc_u32 s59, s59, 0
  s_barrier
  s_waitcnt lgkmcnt(0)
  s_add_u32 s24, s24, 1
  s_branch L_ld_entry
.p2align 6
L_ld:
  s_add_u32 s49, s49, 1
  s_add_u32 s48, s48, 16
  s_sub_u32 s52, s52, s50
  s_add_u32 s52, s52, 16384
  s_and_b32 s52, s52, 65535
  s_add_u32 s52, s52, s50
  s_waitcnt lgkmcnt(0)
  v_readfirstlane_b32 s41, v12
  s_lshl_b32 s43, s49, 1
  s_sub_u32 s43, s43, 7
  s_cmp_lt_i32 s41, s43
  s_cbranch_scc0 L_ld_fb0
  s_swappc_b64 s[60:61], s[58:59]
L_ld_fb0:
  s_cmp_ge_u32 s49, 59
  s_cbranch_scc1 L_dyn2
  s_add_u32 s40, s40, 262144
  s_and_b32 s40, s40, 16777215
L_dynback:
  s_waitcnt vmcnt(10)
  s_add_u32 m0, s52, 0
  s_nop 0
  buffer_load_dwordx4 v2, s[32:35], s40 offen offset:0 nt lds
  s_waitcnt vmcnt(10)
  s_add_u32 m0, s52, 896
  s_nop 0
  buffer_load_dwordx4 v2, s[32:35], s40 offen offset:128 nt lds
  s_waitcnt vmcnt(10)
  v_mov_b32 v11, s46
  ds_write_b32 v6, v11
  s_add_u32 m0, s52, 0
  s_nop 0
  buffer_load_dwordx4 v2, s[32:35], s40 offen offset:2048 nt lds
  s_waitcnt vmcnt(10)
  s_add_u32 m0, s52, 896
  s_nop 0
  buffer_load_dwordx4 v2, s[32:35], s40 offen offset:2176 nt lds
  s_mov_b32 s46, s45
  s_mov_b32 s45, s44
  s_add_u32 s44, s48, 4
  ds_read_b32 v12, v7
  s_waitcnt vmcnt(10)
  s_add_u32 m0, s52, 4096
  s_nop 0
  buffer_load_dwordx4 v3, s[32:35], s40 offen offset:0 nt lds
  s_waitcnt vmcnt(10)
  s_add_u32 m0, s52, 4992
  s_nop 0
  buffer_load_dwordx4 v3, s[32:35], s40 offen offset:128 nt lds
  s_waitcnt vmcnt(10)
  v_mov_b32 v11, s46
  ds_write_b32 v6, v11
  s_add_u32 m0, s52, 4096
  s_nop 0
  buffer_load_dwordx4 v3, s[32:35], s40 offen offset:2048 nt lds
  s_add_u32 s54, s49, 2
  v_mov_b32 v14, s54
  ds_write_b32 v8, v14
  s_waitcnt vmcnt(10)
  s_add_u32 m0, s52, 4992
  s_nop 0
  buffer_load_dwordx4 v3, s[32:35], s40 offen offset:2176 nt lds
  s_mov_b32 s46, s45
  s_mov_b32 s45, s44
  s_add_u32 s44, s48, 8
L_q2entry:
  s_waitcnt lgkmcnt(0)
  v_readfirstlane_b32 s41, v12
  s_add_u32 s43, s43, 1
  s_cmp_lt_i32 s41, s43
  s_cbranch_scc0 L_ld_fb8
  s_swappc_b64 s[60:61], s[58:59]
L_ld_fb8:
  s_waitcnt vmcnt(10)
  s_add_u32 m0, s52, 8192
  s_nop 0
  buffer_load_dwordx4 v4, s[36:39], s40 offen offset:0 nt lds
  s_waitcnt vmcnt(10)
  s_add_u32 m0, s52, 8192
  s_nop 0
  buffer_load_dwordx4 v4, s[36:39], s40 offen offset:1024 nt lds
  s_waitcnt vmcnt(10)
  v_mov_b32 v11, s46
  ds_write_b32 v6, v11
  s_add_u32 m0, s52, 8192
  s_nop 0
  buffer_load_dwordx4 v4, s[36:39], s40 offen offset:2048 nt lds
L_ld_entry:
  s_waitcnt vmcnt(10)
  s_add_u32 m0, s52, 8192
  s_nop 0
  buffer_load_dwordx4 v4, s[36:39], s40 offen offset:3072 nt lds
  s_mov_b32 s46, s45
  s_mov_b32 s45, s44
  s_add_u32 s44, s48, 12
  ds_read_b32 v12, v7
  s_waitcnt vmcnt(10)
  s_add_u32 m0, s52, 12288
  s_nop 0
  buffer_load_dwordx4 v5, s[36:39], s40 offen offset:0 nt lds
  s_waitcnt vmcnt(10)
  s_add_u32 m0, s52, 12288
  s_nop 0
  buffer_load_dwordx4 v5, s[36:39], s40 offen offset:1024 nt lds
  s_waitcnt vmcnt(10)
  v_mov_b32 v11, s46
  ds_write_b32 v6, v11
  s_add_u32 m0, s52, 12288
  s_nop 0
  buffer_load_dwordx4 v5, s[36:39], s40 offen offset:2048 nt lds
  s_add_u32 s55, s49, 1
  s_and_b32 s55, s55, 3
  s_lshl_b32 s55, s55, 2
  v_add_u32 v15, s55, v9
  ds_read_b32 v16, v15
  s_waitcnt vmcnt(10)
  s_add_u32 m0, s52, 12288
  s_nop 0
  buffer_load_dwordx4 v5, s[36:39], s40 offen offset:3072 nt lds
  s_mov_b32 s46, s45
  s_mov_b32 s45, s44
  s_add_u32 s44, s48, 16
  s_branch L_ld
L_ld_full:
  s_waitcnt vmcnt(8)
  v_mov_b32 v11, s46
  ds_write_b32 v6, v11
  ds_read_b32 v12, v7
  s_waitcnt lgkmcnt(0)
  v_readfirstlane_b32 s41, v12
  s_nop 0
  s_cmp_ge_i32 s41, s43
  s_cbranch_scc1 L_ld_fullret
  s_waitcnt vmcnt(4)
  v_mov_b32 v11, s45
  ds_write_b32 v6, v11
  ds_read_b32 v12, v7
  s_waitcnt lgkmcnt(0)
  v_readfirstlane_b32 s41, v12
  s_nop 0
  s_cmp_ge_i32 s41, s43
  s_cbranch_scc1 L_ld_fullret
  s_waitcnt vmcnt(0)
  v_mov_b32 v11, s44
  ds_write_b32 v6, v11
  ds_read_b32 v12, v7
  s_waitcnt lgkmcnt(0)
  v_readfirstlane_b32 s41, v12
  s_nop 0
  s_cmp_ge_i32 s41, s43
  s_cbranch_scc1 L_ld_fullret
  s_mov_b32 s55, 200000
L_ld_fullw:
  ds_read_b32 v12, v7
  s_waitcnt lgkmcnt(0)
  v_readfirstlane_b32 s41, v12
  s_nop 0
  s_cmp_ge_i32 s41, s43
  s_cbranch_scc1 L_ld_fullret
  s_sleep 1
  s_sub_u32 s55, s55, 1
  s_cbranch_scc0 L_ld_fullw
L_ld_fullret:
  s_setpc_b64 s[60:61]
L_dyn2:
  v_readfirstlane_b32 s55, v16
  s_mov_b32 s54, 200000
  s_lshr_b32 s56, s55, 16
  s_cmp_eq_u32 s56, s49
  s_cbranch_scc1 L_dynok
L_dynpoll:
  ds_read_b32 v14, v15
  s_waitcnt lgkmcnt(0)
  v_readfirstlane_b32 s55, v14
  s_nop 0
  s_lshr_b32 s56, s55, 16
  s_cmp_eq_u32 s56, s49
  s_cbranch_scc1 L_dynok
  s_sub_u32 s54, s54, 1
  s_cbranch_scc0 L_dynpoll
  s_mov_b32 s55, 0xffff
L_dynok:
  s_and_b32 s55, s55, 0xffff
  s_cmp_ge_u32 s55, 160
  s_cbranch_scc1 L_ld_stop
  s_add_u32 s55, s55, s47
  s_mul_i32 s55, s55, 8192
  s_and_b32 s40, s55, 16777215
  s_branch L_dynback
L_ld_stop:
  v_mov_b32 v14, 133264
  v_mov_b32 v15, 1
  ds_write_b32 v14, v15
  s_waitcnt vmcnt(8)
  v_mov_b32 v11, s46
  ds_write_b32 v6, v11
  s_waitcnt vmcnt(4)
  v_mov_b32 v11, s45
  ds_write_b32 v6, v11
  s_waitcnt vmcnt(0)
  s_or_b32 s53, s44, 0x80000000
  v_mov_b32 v11, s53
  ds_write_b32 v6, v11
  s_waitcnt lgkmcnt(0)
  s_cmp_lt_u32 s2, 184
  s_cbranch_scc1 L_stream_end
  s_barrier
  s_branch L_finpoll
.p2align 6
L_consumer:
  s_mul_i32 s53, s3, 65536
  v_lshlrev_b32 v3, 4, v0
  v_add_u32 v3, s53, v3
  v_mov_b32 v2, v3
  v_lshrrev_b32 v9, 4, v0
  v_lshlrev_b32 v234, 2, v9
  s_mov_b32 s44, 0x00ff00ff
  s_mov_b32 s45, 0x00ff00ff
  s_mov_b32 s46, 0
  s_mov_b32 s47, -1
  v_bfe_u32 v8, v0, 3, 1
  v_lshlrev_b32 v8, 1, v8
  v_add_u32 v9, 1, v8
  v_lshl_or_b32 v8, v9, 8, v8
  v_or_b32 v9, 0x0c0c0000, v8
  v_lshlrev_b32 v10, 16, v8
  v_or_b32 v10, 0x0c0c, v10
  v_and_b32 v11, 1, v0
  v_cmp_eq_u32 vcc, 1, v11
  s_nop 1
  v_cndmask_b32 v8, v9, v10, vcc
  v_bfe_u32 v11, v0, 1, 2
  v_mov_b32 v9, 0x0c0c0c0c
  v_cmp_eq_u32 vcc, 0, v11
  s_nop 1
  v_cndmask_b32 v180, v9, v8, vcc
  v_cmp_eq_u32 vcc, 1, v11
  s_nop 1
  v_cndmask_b32 v181, v9, v8, vcc
  v_cmp_eq_u32 vcc, 2, v11
  s_nop 1
  v_cndmask_b32 v182, v9, v8, vcc
  v_cmp_eq_u32 vcc, 3, v11
  s_nop 1
  v_cndmask_b32 v183, v9, v8, vcc
  s_lshl_b32 s54, s3, 3
  s_add_u32 s55, s54, 133216
  v_mov_b32 v4, s55
  s_add_u32 s55, s54, 133232
  v_mov_b32 v5, s55
  v_bfe_u32 v8, v0, 1, 1
  v_lshlrev_b32 v8, 8, v8
  v_and_b32 v9, 1, v0
  v_lshl_add_u32 v8, v9, 6, v8
  v_lshrrev_b32 v9, 4, v0
  v_lshl_add_u32 v8, v9, 4, v8
  v_add_u32 v20, 132352, v8
  s_getpc_b64 s[58:59]
L_pcr:
  s_add_u32 s56, s58, L_arrpoll-L_pcr
  s_addc_u32 s57, s59, 0
  s_add_u32 s58, s58, L_rare-L_pcr
  s_addc_u32 s59, s59, 0
  s_mov_b32 s42, 0xff800000
  s_mov_b32 s43, 0xff800000
  s_mov_b32 s48, 0
  s_mov_b32 s51, 0
  v_mov_b32 v21, 0xff800000
  s_mov_b64 s[40:41], 0
  s_waitcnt lgkmcnt(0)
  s_load_dword s24, s[22:23], 0
  s_mov_b32 s28, s22
  s_and_b32 s29, s23, 0xffff
  s_mov_b32 s30, 7340032
  s_mov_b32 s31, 0x20000
  s_barrier
  s_mov_b32 s52, 1
  s_mov_b32 s49, 0x7fffffff
  s_branch L_loop
L_qwait:
  s_waitcnt lgkmcnt(0)
  s_add_u32 s24, s24, 1
  v_mov_b32 v8, 133248
  s_mov_b32 s54, 200000
L_qpoll:
  ds_read_b128 v[12:15], v8
  s_waitcnt lgkmcnt(0)
  v_and_b32 v12, v12, v13
  v_and_b32 v14, v14, v15
  v_and_b32 v12, v12, v14
  s_nop 0
  v_readfirstlane_b32 s60, v12
  s_cmp_lg_u32 s60, 0
  s_cbranch_scc1 L_qok
  s_sleep 1
  s_sub_u32 s54, s54, 1
  s_cbranch_scc0 L_qpoll
L_qok:
  ds_read_b128 v[12:15], v20
  ds_read_b128 v[16:19], v20 offset:128
  v_mov_b32 v2, v3
  s_mov_b32 s51, 0
  s_mov_b32 s48, 0
  s_mov_b32 s49, 0
  s_mov_b32 s52, 0
  s_mov_b32 s63, -1
  v_mov_b32 v168, 0
  v_mov_b32 v169, 0
  v_mov_b32 v170, 0
  v_mov_b32 v171, 0
  v_mov_b32 v192, 0
  v_mov_b32 v193, 0
  s_mov_b32 s42, 0xff800000
  s_mov_b32 s43, 0xff800000
  s_mov_b32 s54, 0xf000f
  s_mov_b32 s55, 0xf000f
  s_waitcnt lgkmcnt(0)
  v_cndmask_b32 v128, 0, v12, s[54:55]
  v_cndmask_b32 v129, 0, v13, s[54:55]
  v_cndmask_b32 v130, 0, v14, s[54:55]
  v_cndmask_b32 v131, 0, v15, s[54:55]
  v_cndmask_b32 v132, 0, v16, s[54:55]
  v_cndmask_b32 v133, 0, v17, s[54:55]
  v_cndmask_b32 v134, 0, v18, s[54:55]
  v_cndmask_b32 v135, 0, v19, s[54:55]
  s_mov_b32 s54, 0xf000f0
  s_mov_b32 s55, 0xf000f0
  v_cndmask_b32 v136, 0, v12, s[54:55]
  v_cndmask_b32 v137, 0, v13, s[54:55]
  v_cndmask_b32 v138, 0, v14, s[54:55]
  v_cndmask_b32 v139, 0, v15, s[54:55]
  v_cndmask_b32 v140, 0, v16, s[54:55]
  v_cndmask_b32 v141, 0, v17, s[54:55]
  v_cndmask_b32 v142, 0, v18, s[54:55]
  v_cndmask_b32 v143, 0, v19, s[54:55]
  s_mov_b32 s54, 0xf000f00
  s_mov_b32 s55, 0xf000f00
  v_cndmask_b32 v144, 0, v12, s[54:55]
  v_cndmask_b32 v145, 0, v13, s[54:55]
  v_cndmask_b32 v146, 0, v14, s[54:55]
  v_cndmask_b32 v147, 0, v15, s[54:55]
  v_cndmask_b32 v148, 0, v16, s[54:55]
  v_cndmask_b32 v149, 0, v17, s[54:55]
  v_cndmask_b32 v150, 0, v18, s[54:55]
  v_cndmask_b32 v151, 0, v19, s[54:55]
  s_mov_b32 s54, 0xf000f000
  s_mov_b32 s55, 0xf000f000
  v_cndmask_b32 v152, 0, v12, s[54:55]
  v_cndmask_b32 v153, 0, v13, s[54:55]
  v_cndmask_b32 v154, 0, v14, s[54:55]
  v_cndmask_b32 v155, 0, v15, s[54:55]
  v_cndmask_b32 v156, 0, v16, s[54:55]
  v_cndmask_b32 v157, 0, v17, s[54:55]
  v_cndmask_b32 v158, 0, v18, s[54:55]
  v_cndmask_b32 v159, 0, v19, s[54:55]
.p2align 6
L_loop:
  s_lshl_b32 s50, s48, 4
  s_add_u32 s50, s50, 4
  s_cmp_ge_u32 s49, s50
  s_cbranch_scc1 L_av_1
  s_swappc_b64 s[60:61], s[56:57]
L_av_1:
  ds_read_b128 v[200:203], v2 offset:0
  ds_read_b128 v[204:207], v2 offset:1024
  ds_read_b128 v[208:211], v2 offset:2048
  ds_read_b128 v[212:215], v2 offset:3072
  s_lshl_b32 s50, s48, 4
  s_add_u32 s50, s50, 8
  s_cmp_ge_u32 s49, s50
  s_cbranch_scc1 L_av_2
  s_swappc_b64 s[60:61], s[56:57]
L_av_2:
  ds_read_b128 v[216:219], v2 offset:4096
  ds_read_b128 v[220:223], v2 offset:5120
  ds_read_b128 v[224:227], v2 offset:6144
  ds_read_b128 v[228:231], v2 offset:7168
  s_waitcnt lgkmcnt(7)
  v_mfma_f32_16x16x32_bf16 v[160:163], v[128:131], v[200:203], 0
  s_waitcnt lgkmcnt(6)
  v_mfma_f32_16x16x32_bf16 v[160:163], v[132:135], v[204:207], v[160:163]
  s_waitcnt lgkmcnt(5)
  v_mfma_f32_16x16x32_bf16 v[160:163], v[136:139], v[208:211], v[160:163]
  s_waitcnt lgkmcnt(4)
  v_mfma_f32_16x16x32_bf16 v[160:163], v[140:143], v[212:215], v[160:163]
  s_waitcnt lgkmcnt(3)
  v_mfma_f32_16x16x32_bf16 v[160:163], v[144:147], v[216:219], v[160:163]
  s_waitcnt lgkmcnt(2)
  v_mfma_f32_16x16x32_bf16 v[160:163], v[148:151], v[220:223], v[160:163]
  s_waitcnt lgkmcnt(1)
  v_mfma_f32_16x16x32_bf16 v[160:163], v[152:155], v[224:227], v[160:163]
  s_waitcnt lgkmcnt(0)
  v_mfma_f32_16x16x32_bf16 v[160:163], v[156:159], v[228:231], v[160:163]
L_kdone:
  s_lshl_b32 s54, s48, 1
  s_add_u32 s54, s54, 1
  s_sub_u32 s54, s54, s52
  v_mov_b32 v7, s54
  s_cmp_lg_u32 s52, 0
  s_cbranch_scc1 L_nofk
  ds_write_b32 v5, v7
L_nofk:
  s_nop 3
  v_cndmask_b32 v188, v161, v160, s[44:45]
  v_cndmask_b32 v190, v163, v162, s[44:45]
  s_nop 0
  v_add_f32_dpp v186, v188, v188 row_ror:8 row_mask:0xf bank_mask:0xf
  v_add_f32_dpp v187, v190, v190 row_ror:8 row_mask:0xf bank_mask:0xf
  v_cvt_pk_bf16_f32 v194, v186, v187
  v_lshlrev_b32 v186, 16, v194
  v_and_b32 v187, 0xffff0000, v194
  v_mul_f32 v186, 0x3db504f3, v186
  v_mul_f32 v187, 0x3db504f3, v187
  v_cvt_pk_bf16_f32 v194, v186, v187
  v_lshlrev_b32 v186, 16, v194
  v_and_b32 v187, 0xffff0000, v194
  v_cmp_lt_f32 vcc, s42, v186
  v_cmp_lt_f32 s[54:55], s43, v187
  s_or_b64 vcc, vcc, s[54:55]
  s_cbranch_scc0 L_nomax_3
  s_swappc_b64 s[60:61], s[58:59]
L_nomax_3:
  v_subrev_f32 v186, s42, v186
  v_subrev_f32 v187, s43, v187
  v_mul_f32 v186, 0x3fb8aa3b, v186
  v_mul_f32 v187, 0x3fb8aa3b, v187
  v_exp_f32 v186, v186
  v_exp_f32 v187, v187
  s_nop 0
  v_add_f32 v192, v192, v186
  v_add_f32 v193, v193, v187
  v_cvt_pk_bf16_f32 v184, v186, v187
  ds_bpermute_b32 v236, v234, v184 offset:0
  ds_bpermute_b32 v237, v234, v184 offset:16
  ds_bpermute_b32 v238, v234, v184 offset:64
  ds_bpermute_b32 v239, v234, v184 offset:80
  ds_bpermute_b32 v240, v234, v184 offset:128
  ds_bpermute_b32 v241, v234, v184 offset:144
  ds_bpermute_b32 v242, v234, v184 offset:192
  ds_bpermute_b32 v243, v234, v184 offset:208
  s_lshl_b32 s50, s48, 4
  s_add_u32 s50, s50, 12
  s_cmp_ge_u32 s49, s50
  s_cbranch_scc1 L_av_4
  s_swappc_b64 s[60:61], s[56:57]
L_av_4:
  ds_read_b128 v[200:203], v2 offset:8192
  ds_read_b128 v[204:207], v2 offset:9216
  ds_read_b128 v[208:211], v2 offset:10240
  ds_read_b128 v[212:215], v2 offset:11264
  s_waitcnt lgkmcnt(4)
  v_perm_b32 v172, v236, v236, v180
  v_perm_b32 v173, v236, v236, v181
  v_perm_b32 v174, v236, v236, v182
  v_perm_b32 v175, v236, v236, v183
  s_waitcnt lgkmcnt(3)
  s_nop 0
  v_mfma_f32_16x16x32_bf16 v[168:171], v[172:175], v[200:203], v[168:171]
  v_perm_b32 v176, v237, v237, v180
  v_perm_b32 v177, v237, v237, v181
  v_perm_b32 v178, v237, v237, v182
  v_perm_b32 v179, v237, v237, v183
  s_waitcnt lgkmcnt(2)
  s_nop 0
  v_mfma_f32_16x16x32_bf16 v[168:171], v[176:179], v[204:207], v[168:171]
  v_perm_b32 v172, v238, v238, v180
  v_perm_b32 v173, v238, v238, v181
  v_perm_b32 v174, v238, v238, v182
  v_perm_b32 v175, v238, v238, v183
  s_waitcnt lgkmcnt(1)
  s_nop 0
  v_mfma_f32_16x16x32_bf16 v[168:171], v[172:175], v[208:211], v[168:171]
  v_perm_b32 v176, v239, v239, v180
  v_perm_b32 v177, v239, v239, v181
  v_perm_b32 v178, v239, v239, v182
  v_perm_b32 v179, v239, v239, v183
  s_waitcnt lgkmcnt(0)
  s_nop 0
  v_mfma_f32_16x16x32_bf16 v[168:171], v[176:179], v[212:215], v[168:171]
  s_lshl_b32 s50, s48, 4
  s_add_u32 s50, s50, 16
  s_cmp_ge_u32 s49, s50
  s_cbranch_scc1 L_av_5
  s_swappc_b64 s[60:61], s[56:57]
L_av_5:
  ds_read_b128 v[216:219], v2 offset:12288
  ds_read_b128 v[220:223], v2 offset:13312
  ds_read_b128 v[224:227], v2 offset:14336
  ds_read_b128 v[228:231], v2 offset:15360
  v_perm_b32 v172, v240, v240, v180
  v_perm_b32 v173, v240, v240, v181
  v_perm_b32 v174, v240, v240, v182
  v_perm_b32 v175, v240, v240, v183
  s_waitcnt lgkmcnt(3)
  s_nop 0
  v_mfma_f32_16x16x32_bf16 v[168:171], v[172:175], v[216:219], v[168:171]
  v_perm_b32 v176, v241, v241, v180
  v_perm_b32 v177, v241, v241, v181
  v_perm_b32 v178, v241, v241, v182
  v_perm_b32 v179, v241, v241, v183
  s_waitcnt lgkmcnt(2)
  s_nop 0
  v_mfma_f32_16x16x32_bf16 v[168:171], v[176:179], v[220:223], v[168:171]
  v_perm_b32 v172, v242, v242, v180
  v_perm_b32 v173, v242, v242, v181
  v_perm_b32 v174, v242, v242, v182
  v_perm_b32 v175, v242, v242, v183
  s_waitcnt lgkmcnt(1)
  s_nop 0
  v_mfma_f32_16x16x32_bf16 v[168:171], v[172:175], v[224:227], v[168:171]
  v_perm_b32 v176, v243, v243, v180
  v_perm_b32 v177, v243, v243, v181
  v_perm_b32 v178, v243, v243, v182
  v_perm_b32 v179, v243, v243, v183
  s_waitcnt lgkmcnt(0)
  s_nop 0
  v_mfma_f32_16x16x32_bf16 v[168:171], v[176:179], v[228:231], v[168:171]
L_vdone:
  s_add_u32 s48, s48, 1
  s_cmp_lg_u32 s52, 0
  s_cbranch_scc1 L_qwait
  s_lshl_b32 s54, s48, 4
  s_cmp_eq_u32 s54, s63
  s_cbranch_scc1 L_done
  s_lshl_b32 s54, s48, 1
  v_mov_b32 v7, s54
  ds_write_b32 v5, v7
  v_mov_b32 v7, s48
  v_mov_b32 v195, 133120
  ds_write_b32 v195, v7
  s_add_u32 s51, s51, 16384
  s_and_b32 s51, s51, 65535
  v_add_u32 v2, s51, v3
  s_branch L_loop
L_arrpoll:
  s_mov_b32 s54, 200000
L_arrpoll2:
  ds_read_b32 v195, v4
  s_waitcnt lgkmcnt(0)
  v_readfirstlane_b32 s62, v195
  s_nop 0
  s_and_b32 s55, s62, 0x7fffffff
  s_max_u32 s49, s49, s55
  s_bitcmp1_b32 s62, 31
  s_cselect_b32 s63, s55, s63
  s_cmp_ge_u32 s49, s50
  s_cbranch_scc1 L_arrret
  s_bitcmp1_b32 s62, 31
  s_cbranch_scc1 L_done
  s_sub_u32 s54, s54, 1
  s_cbranch_scc0 L_arrpoll2
  s_branch L_done
L_arrret:
  s_setpc_b64 s[60:61]
L_done:
  s_nop 7
  s_mul_i32 s53, s3, 1152
  s_add_u32 s53, s53, 133376
  v_lshlrev_b32 v199, 4, v0
  v_add_u32 v199, s53, v199
  ds_write_b128 v199, v[168:171]
  s_nop 0
  v_add_f32_dpp v192, v192, v192 row_ror:8 row_mask:0xf bank_mask:0xf
  v_add_f32_dpp v193, v193, v193 row_ror:8 row_mask:0xf bank_mask:0xf
  s_nop 0
  v_add_f32_dpp v192, v192, v192 row_ror:4 row_mask:0xf bank_mask:0xf
  v_add_f32_dpp v193, v193, v193 row_ror:4 row_mask:0xf bank_mask:0xf
  s_nop 0
  v_add_f32_dpp v192, v192, v192 row_ror:2 row_mask:0xf bank_mask:0xf
  v_add_f32_dpp v193, v193, v193 row_ror:2 row_mask:0xf bank_mask:0xf
  s_nop 0
  v_add_f32_dpp v192, v192, v192 row_ror:1 row_mask:0xf bank_mask:0xf
  v_add_f32_dpp v193, v193, v193 row_ror:1 row_mask:0xf bank_mask:0xf
  v_mov_b32 v196, v192
  v_mov_b32 v197, v193
  s_nop 1
  v_permlane16_swap_b32 v192, v196
  v_permlane16_swap_b32 v193, v197
  s_nop 0
  v_add_f32 v192, v192, v196
  v_add_f32 v193, v193, v197
  v_mov_b32 v196, v192
  v_mov_b32 v197, v193
  s_nop 1
  v_permlane32_swap_b32 v192, v196
  v_permlane32_swap_b32 v193, v197
  s_nop 0
  v_add_f32 v192, v192, v196
  v_add_f32 v193, v193, v197
  v_mov_b32 v200, s42
  v_mov_b32 v201, s43
  v_mul_f32 v202, 0.5, v192
  v_mul_f32 v203, 0.5, v193
  v_mov_b32 v199, s53
  s_mov_b64 exec, 1
  ds_write_b128 v199, v[200:203] offset:1024
  s_mov_b64 exec, -1
  s_waitcnt lgkmcnt(0)
  s_barrier
  s_cmp_lt_u32 s2, 184
  s_cbranch_scc1 L_stream_end
L_finpoll:
  s_sub_u32 s50, s2, 184
  v_lshrrev_b32 v25, 2, v0
  v_mul_u32_u24 v25, 4608, v25
  v_and_b32 v26, 3, v0
  v_lshl_add_u32 v25, v26, 4, v25
  s_lshl_b32 s51, s50, 6
  v_add_u32 v25, s51, v25
  s_mul_i32 s56, s3, 294912
  s_add_u32 s56, s56, 4194304
  s_add_u32 s57, s56, 73728
  s_add_u32 s58, s57, 73728
  s_add_u32 s59, s58, 73728
  s_barrier
  buffer_load_dwordx4 v[64:67], v25, s[28:31], s56 offen sc1
  buffer_load_dwordx4 v[68:71], v25, s[28:31], s57 offen sc1
  buffer_load_dwordx4 v[72:75], v25, s[28:31], s58 offen sc1
  buffer_load_dwordx4 v[76:79], v25, s[28:31], s59 offen sc1
  s_sleep 8
  buffer_load_dwordx4 v[80:83], v25, s[28:31], s56 offen sc1
  buffer_load_dwordx4 v[84:87], v25, s[28:31], s57 offen sc1
  buffer_load_dwordx4 v[88:91], v25, s[28:31], s58 offen sc1
  buffer_load_dwordx4 v[92:95], v25, s[28:31], s59 offen sc1
  s_mov_b32 s53, 200000
L_ap_loop:
  s_waitcnt vmcnt(4)
  v_cmp_ne_u32 vcc, s24, v65
  v_cmp_ne_u32 s[40:41], s24, v67
  s_or_b64 s[40:41], s[40:41], vcc
  v_cmp_ne_u32 vcc, s24, v69
  v_cmp_ne_u32 s[42:43], s24, v71
  s_or_b64 s[42:43], s[42:43], vcc
  v_cmp_ne_u32 vcc, s24, v73
  v_cmp_ne_u32 s[44:45], s24, v75
  s_or_b64 s[44:45], s[44:45], vcc
  v_cmp_ne_u32 vcc, s24, v77
  v_cmp_ne_u32 s[46:47], s24, v79
  s_or_b64 s[46:47], s[46:47], vcc
  s_mov_b64 s[48:49], s[40:41]
  s_or_b64 s[48:49], s[48:49], s[42:43]
  s_or_b64 s[48:49], s[48:49], s[44:45]
  s_or_b64 s[48:49], s[48:49], s[46:47]
  s_cmp_eq_u64 s[48:49], 0
  s_cbranch_scc1 L_ap_A
  s_or_b32 exec_lo, s40, 1
  s_mov_b32 exec_hi, s41
  buffer_load_dwordx4 v[64:67], v25, s[28:31], s56 offen sc1
  s_or_b32 exec_lo, s42, 1
  s_mov_b32 exec_hi, s43
  buffer_load_dwordx4 v[68:71], v25, s[28:31], s57 offen sc1
  s_or_b32 exec_lo, s44, 1
  s_mov_b32 exec_hi, s45
  buffer_load_dwordx4 v[72:75], v25, s[28:31], s58 offen sc1
  s_or_b32 exec_lo, s46, 1
  s_mov_b32 exec_hi, s47
  buffer_load_dwordx4 v[76:79], v25, s[28:31], s59 offen sc1
  s_mov_b64 exec, -1
  s_waitcnt vmcnt(4)
  v_cmp_ne_u32 vcc, s24, v81
  v_cmp_ne_u32 s[40:41], s24, v83
  s_or_b64 s[40:41], s[40:41], vcc
  v_cmp_ne_u32 vcc, s24, v85
  v_cmp_ne_u32 s[42:43], s24, v87
  s_or_b64 s[42:43], s[42:43], vcc
  v_cmp_ne_u32 vcc, s24, v89
  v_cmp_ne_u32 s[44:45], s24, v91
  s_or_b64 s[44:45], s[44:45], vcc
  v_cmp_ne_u32 vcc, s24, v93
  v_cmp_ne_u32 s[46:47], s24, v95
  s_or_b64 s[46:47], s[46:47], vcc
  s_mov_b64 s[48:49], s[40:41]
  s_or_b64 s[48:49], s[48:49], s[42:43]
  s_or_b64 s[48:49], s[48:49], s[44:45]
  s_or_b64 s[48:49], s[48:49], s[46:47]
  s_cmp_eq_u64 s[48:49], 0
  s_cbranch_scc1 L_ap_B
  s_or_b32 exec_lo, s40, 1
  s_mov_b32 exec_hi, s41
  buffer_load_dwordx4 v[80:83], v25, s[28:31], s56 offen sc1
  s_or_b32 exec_lo, s42, 1
  s_mov_b32 exec_hi, s43
  buffer_load_dwordx4 v[84:87], v25, s[28:31], s57 offen sc1
  s_or_b32 exec_lo, s44, 1
  s_mov_b32 exec_hi, s45
  buffer_load_dwordx4 v[88:91], v25, s[28:31], s58 offen sc1
  s_or_b32 exec_lo, s46, 1
  s_mov_b32 exec_hi, s47
  buffer_load_dwordx4 v[92:95], v25, s[28:31], s59 offen sc1
  s_mov_b64 exec, -1
  s_sub_u32 s53, s53, 1
  s_cbranch_scc0 L_ap_loop
L_ap_A:
  v_add_f32 v28, v64, v68
  v_add_f32 v29, v66, v70
  v_add_f32 v28, v28, v72
  v_add_f32 v29, v29, v74
  v_add_f32 v28, v28, v76
  v_add_f32 v29, v29, v78
  s_branch L_ap_done
L_ap_B:
  v_add_f32 v28, v80, v84
  v_add_f32 v29, v82, v86
  v_add_f32 v28, v28, v88
  v_add_f32 v29, v29, v90
  v_add_f32 v28, v28, v92
  v_add_f32 v29, v29, v94
L_ap_done:
  s_nop 0
  v_add_f32_dpp v28, v28, v28 row_ror:4 row_mask:0xf bank_mask:0xf
  v_add_f32_dpp v29, v29, v29 row_ror:4 row_mask:0xf bank_mask:0xf
  s_nop 0
  v_add_f32_dpp v28, v28, v28 row_ror:8 row_mask:0xf bank_mask:0xf
  v_add_f32_dpp v29, v29, v29 row_ror:8 row_mask:0xf bank_mask:0xf
  v_mov_b32 v27, v28
  v_mov_b32 v26, v29
  s_nop 1
  v_permlane16_swap_b32 v28, v27
  v_permlane16_swap_b32 v29, v26
  s_nop 0
  v_add_f32 v28, v28, v27
  v_add_f32 v29, v29, v26
  v_mov_b32 v27, v28
  v_mov_b32 v26, v29
  s_nop 1
  v_permlane32_swap_b32 v28, v27
  v_permlane32_swap_b32 v29, v26
  s_nop 0
  v_add_f32 v28, v28, v27
  v_add_f32 v29, v29, v26
  s_lshl_b32 s51, s3, 5
  s_add_u32 s51, s51, 137984
  v_lshlrev_b32 v27, 3, v0
  v_add_u32 v27, s51, v27
  s_mov_b64 exec, 0xf
  ds_write_b64 v27, v[28:29]
  s_mov_b64 exec, -1
  s_waitcnt lgkmcnt(0)
  s_barrier
L_stream_end:
  s_endpgm
L_rare:
  v_mov_b32 v194, v186
  v_mov_b32 v195, v187
  s_nop 0
  v_max_f32_dpp v194, v194, v194 row_ror:8 row_mask:0xf bank_mask:0xf
  v_max_f32_dpp v195, v195, v195 row_ror:8 row_mask:0xf bank_mask:0xf
  s_nop 0
  v_max_f32_dpp v194, v194, v194 row_ror:4 row_mask:0xf bank_mask:0xf
  v_max_f32_dpp v195, v195, v195 row_ror:4 row_mask:0xf bank_mask:0xf
  s_nop 0
  v_max_f32_dpp v194, v194, v194 row_ror:2 row_mask:0xf bank_mask:0xf
  v_max_f32_dpp v195, v195, v195 row_ror:2 row_mask:0xf bank_mask:0xf
  s_nop 0
  v_max_f32_dpp v194, v194, v194 row_ror:1 row_mask:0xf bank_mask:0xf
  v_max_f32_dpp v195, v195, v195 row_ror:1 row_mask:0xf bank_mask:0xf
  v_mov_b32 v196, v194
  v_mov_b32 v197, v195
  s_nop 1
  v_permlane16_swap_b32 v194, v196
  v_permlane16_swap_b32 v195, v197
  s_nop 0
  v_max_f32 v194, v194, v196
  v_max_f32 v195, v195, v197
  v_mov_b32 v196, v194
  v_mov_b32 v197, v195
  s_nop 1
  v_permlane32_swap_b32 v194, v196
  v_permlane32_swap_b32 v195, v197
  s_nop 0
  v_max_f32 v194, v194, v196
  v_max_f32 v195, v195, v197
  v_max_f32 v194, s42, v194
  v_max_f32 v195, s43, v195
  v_sub_f32 v196, s42, v194
  v_sub_f32 v197, s43, v195
  v_readfirstlane_b32 s42, v194
  v_readfirstlane_b32 s43, v195
  v_mul_f32 v196, 0x3fb8aa3b, v196
  v_mul_f32 v197, 0x3fb8aa3b, v197
  v_exp_f32 v196, v196
  v_exp_f32 v197, v197
  s_nop 0
  v_mul_f32 v192, v192, v196
  v_mul_f32 v193, v193, v197
  v_cndmask_b32 v198, v196, v197, s[46:47]
  v_mul_f32 v168, v168, v198
  v_mul_f32 v169, v169, v198
  v_mul_f32 v170, v170, v198
  v_mul_f32 v171, v171, v198
  s_nop 1
  s_setpc_b64 s[60:61]
.p2align 6
L_helper:
  s_cmp_eq_u32 s3, 6
  s_cbranch_scc0 L_not6
  v_lshlrev_b32 v2, 2, v0
  v_add_u32 v2, 133120, v2
  v_mov_b32 v3, 0
  ds_write_b32 v2, v3
  s_waitcnt lgkmcnt(0)
  s_barrier
  s_load_dword s24, s[22:23], 0
  s_mov_b32 s28, s22
  s_and_b32 s29, s23, 0xffff
  s_mov_b32 s30, 7340032
  s_mov_b32 s31, 0x20000
  s_waitcnt lgkmcnt(0)
  s_add_u32 s24, s24, 1
  s_branch L_gatherwait
L_not6:
  s_waitcnt lgkmcnt(0)
  s_load_dword s24, s[22:23], 0
  s_mov_b32 s28, s22
  s_and_b32 s29, s23, 0xffff
  s_mov_b32 s30, 7340032
  s_mov_b32 s31, 0x20000
  s_cmp_eq_u32 s3, 4
  s_cbranch_scc1 L_w4
  s_barrier
  s_cmp_eq_u32 s3, 5
  s_cbranch_scc1 L_w5
  s_getpc_b64 s[32:33]
L_pc7:
  s_sub_u32 s32, s32, L_pc7-parallel_sum__gqa_block_cached__dense_activation_silu__decode_kernel
  s_subb_u32 s33, s33, 0
  s_and_b32 s33, s33, 0xffff
  s_mov_b32 s34, L_codeend-parallel_sum__gqa_block_cached__dense_activation_silu__decode_kernel
  s_mov_b32 s35, 0x20000
  v_lshlrev_b32 v2, 4, v0
  s_lshr_b32 s36, s2, 3
  s_lshl_b32 s36, s36, 10
  v_add_u32 v2, s36, v2
  buffer_load_dwordx4 v[4:7], v2, s[32:35], 0 offen
  s_waitcnt lgkmcnt(0)
  s_add_u32 s24, s24, 1
  s_and_b32 s36, s26, 15
  s_cmp_eq_u32 s36, 0
  s_cbranch_scc0 L_gatherwait
  s_mul_i32 s36, s25, 1
  s_lshr_b32 s37, s26, 4
  s_add_u32 s36, s36, s37
  s_mul_i32 s36, s36, 4096
  s_add_u32 s36, s36, 5636096
  v_mov_b32 v8, 0
  v_mov_b32 v9, s24
  v_mov_b32 v2, 0
  s_mov_b64 exec, 1
  buffer_store_dwordx2 v[8:9], v2, s[28:31], s36 offen sc1
  s_mov_b64 exec, -1
  s_branch L_gatherwait
L_w4:
  s_mov_b32 s32, s4
  s_and_b32 s33, s5, 0xffff
  s_mov_b32 s34, 1152
  s_mov_b32 s35, 0x20000
  s_mov_b32 s36, s10
  s_and_b32 s37, s11, 0xffff
  s_mov_b32 s38, 4718592
  s_mov_b32 s39, 0x20000
  v_lshlrev_b32 v2, 2, v0
  buffer_load_dword v8, v2, s[32:35], 0 offen offset:0
  buffer_load_dword v9, v2, s[32:35], 0 offen offset:256
  buffer_load_dword v10, v2, s[32:35], 0 offen offset:512
  buffer_load_dword v11, v2, s[32:35], 0 offen offset:768
  buffer_load_dword v12, v2, s[32:35], 0 offen offset:1024
  s_lshr_b32 s40, s2, 3
  s_bfe_u32 s41, s2, 0x10002
  s_lshl_b32 s41, s41, 5
  s_add_u32 s40, s40, s41
  s_and_b32 s41, s2, 3
  s_mul_i32 s42, s41, 1179648
  s_lshl_b32 s43, s40, 7
  s_add_u32 s42, s42, s43
  v_lshrrev_b32 v3, 3, v0
  v_lshlrev_b32 v3, 13, v3
  v_and_b32 v4, 7, v0
  v_lshl_add_u32 v3, v4, 4, v3
  buffer_load_dwordx4 v[64:67], v3, s[36:39], s42 offen nt
  s_add_u32 s42, s42, 65536
  buffer_load_dwordx4 v[68:71], v3, s[36:39], s42 offen nt
  s_add_u32 s42, s42, 65536
  buffer_load_dwordx4 v[72:75], v3, s[36:39], s42 offen nt
  s_add_u32 s42, s42, 65536
  buffer_load_dwordx4 v[76:79], v3, s[36:39], s42 offen nt
  s_add_u32 s42, s42, 65536
  buffer_load_dwordx4 v[80:83], v3, s[36:39], s42 offen nt
  s_add_u32 s42, s42, 65536
  buffer_load_dwordx4 v[84:87], v3, s[36:39], s42 offen nt
  s_add_u32 s42, s42, 65536
  buffer_load_dwordx4 v[88:91], v3, s[36:39], s42 offen nt
  s_add_u32 s42, s42, 65536
  buffer_load_dwordx4 v[92:95], v3, s[36:39], s42 offen nt
  s_add_u32 s42, s42, 65536
  buffer_load_dwordx4 v[96:99], v3, s[36:39], s42 offen nt
  s_add_u32 s42, s42, 65536
  buffer_load_dwordx4 v[100:103], v3, s[36:39], s42 offen nt
  s_add_u32 s42, s42, 65536
  buffer_load_dwordx4 v[104:107], v3, s[36:39], s42 offen nt
  s_add_u32 s42, s42, 65536
  buffer_load_dwordx4 v[108:111], v3, s[36:39], s42 offen nt
  s_add_u32 s42, s42, 65536
  buffer_load_dwordx4 v[112:115], v3, s[36:39], s42 offen nt
  s_add_u32 s42, s42, 65536
  buffer_load_dwordx4 v[116:119], v3, s[36:39], s42 offen nt
  s_add_u32 s42, s42, 65536
  buffer_load_dwordx4 v[120:123], v3, s[36:39], s42 offen nt
  s_add_u32 s42, s42, 65536
  buffer_load_dwordx4 v[124:127], v3, s[36:39], s42 offen nt
  s_add_u32 s42, s42, 65536
  buffer_load_dwordx4 v[128:131], v3, s[36:39], s42 offen nt
  s_add_u32 s42, s42, 65536
  buffer_load_dwordx4 v[132:135], v3, s[36:39], s42 offen nt
  s_barrier
  v_mov_b32 v20, 0
  v_add_u32 v21, 1, v20
  v_lshl_or_b32 v20, v21, 8, v20
  v_or_b32 v21, 0x0c0c0000, v20
  v_lshlrev_b32 v22, 16, v20
  v_or_b32 v22, 0x0c0c, v22
  v_and_b32 v23, 1, v0
  v_cmp_eq_u32 vcc, 1, v23
  s_nop 1
  v_cndmask_b32 v20, v21, v22, vcc
  v_bfe_u32 v23, v0, 1, 2
  v_mov_b32 v21, 0x0c0c0c0c
  v_cmp_eq_u32 vcc, 0, v23
  s_nop 1
  v_cndmask_b32 v16, v21, v20, vcc
  v_cmp_eq_u32 vcc, 1, v23
  s_nop 1
  v_cndmask_b32 v17, v21, v20, vcc
  v_cmp_eq_u32 vcc, 2, v23
  s_nop 1
  v_cndmask_b32 v18, v21, v20, vcc
  v_cmp_eq_u32 vcc, 3, v23
  s_nop 1
  v_cndmask_b32 v19, v21, v20, vcc
  v_and_b32 v5, 7, v0
  v_lshlrev_b32 v5, 6, v5
  v_bfe_u32 v6, v0, 4, 1
  v_lshl_add_u32 v5, v6, 5, v5
  v_bfe_u32 v6, v0, 3, 1
  v_lshl_add_u32 v5, v6, 4, v5
  s_waitcnt vmcnt(18)
  v_lshlrev_b32 v24, 16, v8
  v_and_b32 v25, 0xffff0000, v8
  v_lshlrev_b32 v26, 16, v9
  v_and_b32 v27, 0xffff0000, v9
  v_lshlrev_b32 v28, 16, v10
  v_and_b32 v29, 0xffff0000, v10
  v_lshlrev_b32 v30, 16, v11
  v_and_b32 v31, 0xffff0000, v11
  v_lshlrev_b32 v32, 16, v12
  v_and_b32 v33, 0xffff0000, v12
  v_add_f32 v36, v24, v25
  v_add_f32 v36, v36, v26
  v_add_f32 v36, v36, v27
  v_add_f32 v36, v36, v28
  v_add_f32 v36, v36, v29
  v_add_f32 v36, v36, v30
  v_add_f32 v36, v36, v31
  v_add_f32 v36, v36, v32
  v_add_f32 v36, v36, v33
  s_nop 1
  v_add_f32_dpp v36, v36, v36 row_ror:8 row_mask:0xf bank_mask:0xf
  s_nop 1
  v_add_f32_dpp v36, v36, v36 row_ror:4 row_mask:0xf bank_mask:0xf
  s_nop 1
  v_add_f32_dpp v36, v36, v36 row_ror:2 row_mask:0xf bank_mask:0xf
  s_nop 1
  v_add_f32_dpp v36, v36, v36 row_ror:1 row_mask:0xf bank_mask:0xf
  v_mov_b32 v37, v36
  s_nop 1
  v_permlane16_swap_b32 v36, v37
  s_nop 0
  v_add_f32 v36, v36, v37
  v_mov_b32 v37, v36
  s_nop 1
  v_permlane32_swap_b32 v36, v37
  s_nop 0
  v_add_f32 v36, v36, v37
  v_mov_b32 v38, 0x44100000
  v_mov_b32 v39, 0x3ae38e39
  v_mul_f32 v41, v36, v39
  v_fma_f32 v40, -v41, v38, v36
  v_fma_f32 v41, v40, v39, v41
  v_mov_b32 v36, 0
  v_sub_f32 v37, v24, v41
  v_fma_f32 v36, v37, v37, v36
  v_sub_f32 v37, v25, v41
  v_fma_f32 v36, v37, v37, v36
  v_sub_f32 v37, v26, v41
  v_fma_f32 v36, v37, v37, v36
  v_sub_f32 v37, v27, v41
  v_fma_f32 v36, v37, v37, v36
  v_sub_f32 v37, v28, v41
  v_fma_f32 v36, v37, v37, v36
  v_sub_f32 v37, v29, v41
  v_fma_f32 v36, v37, v37, v36
  v_sub_f32 v37, v30, v41
  v_fma_f32 v36, v37, v37, v36
  v_sub_f32 v37, v31, v41
  v_fma_f32 v36, v37, v37, v36
  s_mov_b32 exec_hi, 0
  v_sub_f32 v37, v32, v41
  v_fma_f32 v36, v37, v37, v36
  v_sub_f32 v37, v33, v41
  v_fma_f32 v36, v37, v37, v36
  s_mov_b32 exec_hi, -1
  s_nop 1
  v_add_f32_dpp v36, v36, v36 row_ror:8 row_mask:0xf bank_mask:0xf
  s_nop 1
  v_add_f32_dpp v36, v36, v36 row_ror:4 row_mask:0xf bank_mask:0xf
  s_nop 1
  v_add_f32_dpp v36, v36, v36 row_ror:2 row_mask:0xf bank_mask:0xf
  s_nop 1
  v_add_f32_dpp v36, v36, v36 row_ror:1 row_mask:0xf bank_mask:0xf
  v_mov_b32 v37, v36
  s_nop 1
  v_permlane16_swap_b32 v36, v37
  s_nop 0
  v_add_f32 v36, v36, v37
  v_mov_b32 v37, v36
  s_nop 1
  v_permlane32_swap_b32 v36, v37
  s_nop 0
  v_add_f32 v36, v36, v37
  v_mul_f32 v43, v36, v39
  v_fma_f32 v40, -v43, v38, v36
  v_fma_f32 v43, v40, v39, v43
  v_cvt_pk_bf16_f32 v37, v43, v41
  v_lshlrev_b32 v43, 16, v37
  v_and_b32 v41, 0xffff0000, v37
  v_add_f32 v43, 0x3727c5ac, v43
  v_cvt_pk_bf16_f32 v37, v43, v43
  v_lshlrev_b32 v43, 16, v37
  v_sqrt_f32 v43, v43
  s_nop 0
  v_cvt_pk_bf16_f32 v37, v43, v43
  v_lshlrev_b32 v42, 16, v37
  v_rcp_f32 v39, v42
  s_nop 0
  v_fma_f32 v40, -v42, v39, 1.0
  v_fma_f32 v39, v40, v39, v39
  v_sub_f32 v24, v24, v41
  v_sub_f32 v25, v25, v41
  v_cvt_pk_bf16_f32 v37, v24, v25
  v_lshlrev_b32 v24, 16, v37
  v_and_b32 v25, 0xffff0000, v37
  v_mul_f32 v36, v24, v39
  v_mul_f32 v43, v25, v39
  v_fma_f32 v40, -v36, v42, v24
  v_fma_f32 v38, -v43, v42, v25
  v_fma_f32 v36, v40, v39, v36
  v_fma_f32 v43, v38, v39, v43
  v_cvt_pk_bf16_f32 v8, v36, v43
  v_sub_f32 v26, v26, v41
  v_sub_f32 v27, v27, v41
  v_cvt_pk_bf16_f32 v37, v26, v27
  v_lshlrev_b32 v26, 16, v37
  v_and_b32 v27, 0xffff0000, v37
  v_mul_f32 v36, v26, v39
  v_mul_f32 v43, v27, v39
  v_fma_f32 v40, -v36, v42, v26
  v_fma_f32 v38, -v43, v42, v27
  v_fma_f32 v36, v40, v39, v36
  v_fma_f32 v43, v38, v39, v43
  v_cvt_pk_bf16_f32 v9, v36, v43
  v_sub_f32 v28, v28, v41
  v_sub_f32 v29, v29, v41
  v_cvt_pk_bf16_f32 v37, v28, v29
  v_lshlrev_b32 v28, 16, v37
  v_and_b32 v29, 0xffff0000, v37
  v_mul_f32 v36, v28, v39
  v_mul_f32 v43, v29, v39
  v_fma_f32 v40, -v36, v42, v28
  v_fma_f32 v38, -v43, v42, v29
  v_fma_f32 v36, v40, v39, v36
  v_fma_f32 v43, v38, v39, v43
  v_cvt_pk_bf16_f32 v10, v36, v43
  v_sub_f32 v30, v30, v41
  v_sub_f32 v31, v31, v41
  v_cvt_pk_bf16_f32 v37, v30, v31
  v_lshlrev_b32 v30, 16, v37
  v_and_b32 v31, 0xffff0000, v37
  v_mul_f32 v36, v30, v39
  v_mul_f32 v43, v31, v39
  v_fma_f32 v40, -v36, v42, v30
  v_fma_f32 v38, -v43, v42, v31
  v_fma_f32 v36, v40, v39, v36
  v_fma_f32 v43, v38, v39, v43
  v_cvt_pk_bf16_f32 v11, v36, v43
  v_sub_f32 v32, v32, v41
  v_sub_f32 v33, v33, v41
  v_cvt_pk_bf16_f32 v37, v32, v33
  v_lshlrev_b32 v32, 16, v37
  v_and_b32 v33, 0xffff0000, v37
  v_mul_f32 v36, v32, v39
  v_mul_f32 v43, v33, v39
  v_fma_f32 v40, -v36, v42, v32
  v_fma_f32 v38, -v43, v42, v33
  v_fma_f32 v36, v40, v39, v36
  v_fma_f32 v43, v38, v39, v43
  v_cvt_pk_bf16_f32 v12, v36, v43
  v_lshlrev_b32 v2, 2, v0
  v_add_u32 v2, 131072, v2
  ds_write_b32 v2, v8 offset:0
  ds_write_b32 v2, v9 offset:256
  ds_write_b32 v2, v10 offset:512
  ds_write_b32 v2, v11 offset:768
  ds_write_b32 v2, v12 offset:1024
  s_mul_i32 s42, s41, 288
  s_add_u32 s42, s42, 131072
  v_lshrrev_b32 v2, 3, v0
  v_lshlrev_b32 v2, 1, v2
  v_add_u32 v2, s42, v2
  s_waitcnt lgkmcnt(0)
  s_add_u32 s24, s24, 1
  ds_read_u16 v24, v2 offset:0
  ds_read_u16 v25, v2 offset:16
  ds_read_u16 v26, v2 offset:32
  ds_read_u16 v27, v2 offset:48
  ds_read_u16 v28, v2 offset:64
  ds_read_u16 v29, v2 offset:80
  ds_read_u16 v30, v2 offset:96
  ds_read_u16 v31, v2 offset:112
  ds_read_u16 v32, v2 offset:128
  ds_read_u16 v33, v2 offset:144
  ds_read_u16 v34, v2 offset:160
  ds_read_u16 v35, v2 offset:176
  ds_read_u16 v36, v2 offset:192
  ds_read_u16 v37, v2 offset:208
  ds_read_u16 v38, v2 offset:224
  ds_read_u16 v39, v2 offset:240
  ds_read_u16 v40, v2 offset:256
  ds_read_u16 v41, v2 offset:272
  v_mov_b32 v6, 133124
  v_mov_b32 v7, 1
  ds_write_b32 v6, v7
  s_waitcnt lgkmcnt(0)
  v_perm_b32 v44, v24, v24, v16
  v_perm_b32 v45, v24, v24, v17
  v_perm_b32 v46, v24, v24, v18
  v_perm_b32 v47, v24, v24, v19
  s_waitcnt vmcnt(17)
  s_nop 0
  v_mfma_f32_16x16x32_bf16 v[52:55], v[44:47], v[64:67], 0
  v_perm_b32 v48, v25, v25, v16
  v_perm_b32 v49, v25, v25, v17
  v_perm_b32 v50, v25, v25, v18
  v_perm_b32 v51, v25, v25, v19
  s_waitcnt vmcnt(16)
  s_nop 0
  v_mfma_f32_16x16x32_bf16 v[52:55], v[48:51], v[68:71], v[52:55]
  v_perm_b32 v44, v26, v26, v16
  v_perm_b32 v45, v26, v26, v17
  v_perm_b32 v46, v26, v26, v18
  v_perm_b32 v47, v26, v26, v19
  s_waitcnt vmcnt(15)
  s_nop 0
  v_mfma_f32_16x16x32_bf16 v[52:55], v[44:47], v[72:75], v[52:55]
  v_perm_b32 v48, v27, v27, v16
  v_perm_b32 v49, v27, v27, v17
  v_perm_b32 v50, v27, v27, v18
  v_perm_b32 v51, v27, v27, v19
  s_waitcnt vmcnt(14)
  s_nop 0
  v_mfma_f32_16x16x32_bf16 v[52:55], v[48:51], v[76:79], v[52:55]
  v_perm_b32 v44, v28, v28, v16
  v_perm_b32 v45, v28, v28, v17
  v_perm_b32 v46, v28, v28, v18
  v_perm_b32 v47, v28, v28, v19
  s_waitcnt vmcnt(13)
  s_nop 0
  v_mfma_f32_16x16x32_bf16 v[52:55], v[44:47], v[80:83], v[52:55]
  v_perm_b32 v48, v29, v29, v16
  v_perm_b32 v49, v29, v29, v17
  v_perm_b32 v50, v29, v29, v18
  v_perm_b32 v51, v29, v29, v19
  s_waitcnt vmcnt(12)
  s_nop 0
  v_mfma_f32_16x16x32_bf16 v[52:55], v[48:51], v[84:87], v[52:55]
  v_perm_b32 v44, v30, v30, v16
  v_perm_b32 v45, v30, v30, v17
  v_perm_b32 v46, v30, v30, v18
  v_perm_b32 v47, v30, v30, v19
  s_waitcnt vmcnt(11)
  s_nop 0
  v_mfma_f32_16x16x32_bf16 v[52:55], v[44:47], v[88:91], v[52:55]
  v_perm_b32 v48, v31, v31, v16
  v_perm_b32 v49, v31, v31, v17
  v_perm_b32 v50, v31, v31, v18
  v_perm_b32 v51, v31, v31, v19
  s_waitcnt vmcnt(10)
  s_nop 0
  v_mfma_f32_16x16x32_bf16 v[52:55], v[48:51], v[92:95], v[52:55]
  v_perm_b32 v44, v32, v32, v16
  v_perm_b32 v45, v32, v32, v17
  v_perm_b32 v46, v32, v32, v18
  v_perm_b32 v47, v32, v32, v19
  s_waitcnt vmcnt(9)
  s_nop 0
  v_mfma_f32_16x16x32_bf16 v[52:55], v[44:47], v[96:99], v[52:55]
  v_perm_b32 v48, v33, v33, v16
  v_perm_b32 v49, v33, v33, v17
  v_perm_b32 v50, v33, v33, v18
  v_perm_b32 v51, v33, v33, v19
  s_waitcnt vmcnt(8)
  s_nop 0
  v_mfma_f32_16x16x32_bf16 v[52:55], v[48:51], v[100:103], v[52:55]
  v_perm_b32 v44, v34, v34, v16
  v_perm_b32 v45, v34, v34, v17
  v_perm_b32 v46, v34, v34, v18
  v_perm_b32 v47, v34, v34, v19
  s_waitcnt vmcnt(7)
  s_nop 0
  v_mfma_f32_16x16x32_bf16 v[52:55], v[44:47], v[104:107], v[52:55]
  v_perm_b32 v48, v35, v35, v16
  v_perm_b32 v49, v35, v35, v17
  v_perm_b32 v50, v35, v35, v18
  v_perm_b32 v51, v35, v35, v19
  s_waitcnt vmcnt(6)
  s_nop 0
  v_mfma_f32_16x16x32_bf16 v[52:55], v[48:51], v[108:111], v[52:55]
  v_perm_b32 v44, v36, v36, v16
  v_perm_b32 v45, v36, v36, v17
  v_perm_b32 v46, v36, v36, v18
  v_perm_b32 v47, v36, v36, v19
  s_waitcnt vmcnt(5)
  s_nop 0
  v_mfma_f32_16x16x32_bf16 v[52:55], v[44:47], v[112:115], v[52:55]
  v_perm_b32 v48, v37, v37, v16
  v_perm_b32 v49, v37, v37, v17
  v_perm_b32 v50, v37, v37, v18
  v_perm_b32 v51, v37, v37, v19
  s_waitcnt vmcnt(4)
  s_nop 0
  v_mfma_f32_16x16x32_bf16 v[52:55], v[48:51], v[116:119], v[52:55]
  v_perm_b32 v44, v38, v38, v16
  v_perm_b32 v45, v38, v38, v17
  v_perm_b32 v46, v38, v38, v18
  v_perm_b32 v47, v38, v38, v19
  s_waitcnt vmcnt(3)
  s_nop 0
  v_mfma_f32_16x16x32_bf16 v[52:55], v[44:47], v[120:123], v[52:55]
  v_perm_b32 v48, v39, v39, v16
  v_perm_b32 v49, v39, v39, v17
  v_perm_b32 v50, v39, v39, v18
  v_perm_b32 v51, v39, v39, v19
  s_waitcnt vmcnt(2)
  s_nop 0
  v_mfma_f32_16x16x32_bf16 v[52:55], v[48:51], v[124:127], v[52:55]
  v_perm_b32 v44, v40, v40, v16
  v_perm_b32 v45, v40, v40, v17
  v_perm_b32 v46, v40, v40, v18
  v_perm_b32 v47, v40, v40, v19
  s_waitcnt vmcnt(1)
  s_nop 0
  v_mfma_f32_16x16x32_bf16 v[52:55], v[44:47], v[128:131], v[52:55]
  v_perm_b32 v48, v41, v41, v16
  v_perm_b32 v49, v41, v41, v17
  v_perm_b32 v50, v41, v41, v18
  v_perm_b32 v51, v41, v41, v19
  s_waitcnt vmcnt(0)
  s_nop 0
  v_mfma_f32_16x16x32_bf16 v[52:55], v[48:51], v[132:135], v[52:55]
  s_nop 7
  v_mov_b32 v56, v52
  v_mov_b32 v57, v53
  v_mov_b32 v58, v54
  v_mov_b32 v59, v55
  s_nop 1
  v_permlane32_swap_b32 v52, v56
  v_permlane32_swap_b32 v53, v57
  v_permlane32_swap_b32 v54, v58
  v_permlane32_swap_b32 v55, v59
  s_nop 1
  v_add_f32_dpp v52, v56, v52 row_ror:8 row_mask:0xf bank_mask:0xf
  v_add_f32_dpp v53, v57, v53 row_ror:8 row_mask:0xf bank_mask:0xf
  v_add_f32_dpp v54, v58, v54 row_ror:8 row_mask:0xf bank_mask:0xf
  v_add_f32_dpp v55, v59, v55 row_ror:8 row_mask:0xf bank_mask:0xf
  s_lshl_b32 s42, s40, 2
  s_add_u32 s42, s42, s41
  s_lshl_b32 s42, s42, 9
  s_add_u32 s42, s42, 4096
  s_nop 1
  v_mov_b32_dpp v52, v54 row_ror:8 row_mask:0xf bank_mask:0xc
  v_mov_b32_dpp v53, v55 row_ror:8 row_mask:0xf bank_mask:0xc
  v_mov_b32 v60, v52
  v_mov_b32 v61, s24
  v_mov_b32 v62, v53
  v_mov_b32 v63, s24
  s_mov_b32 exec_hi, 0
  buffer_store_dwordx4 v[60:63], v5, s[28:31], s42 offen sc1
  s_mov_b32 exec_hi, -1
  v_mov_b32 v6, 133128
  v_mov_b32 v7, 1
  ds_write_b32 v6, v7
  s_branch L_gather
L_w5:
  s_mov_b32 s32, s16
  s_and_b32 s33, s17, 0xffff
  s_mov_b32 s34, 5308416
  s_mov_b32 s35, 0x20000
  s_mov_b32 s36, s18
  s_and_b32 s37, s19, 0xffff
  s_mov_b32 s38, 5308416
  s_mov_b32 s39, 0x20000
  s_mul_i32 s41, s2, 1821
  s_lshr_b32 s41, s41, 16
  s_mul_i32 s40, s41, 36
  s_sub_u32 s40, s2, s40
  s_cmp_ge_u32 s2, 216
  s_cselect_b32 s34, 0, s34
  v_lshrrev_b32 v5, 4, v0
  v_mul_u32_u24 v3, 9216, v5
  v_and_b32 v4, 15, v0
  v_lshl_add_u32 v3, v4, 4, v3
  s_mul_i32 s42, s41, 884736
  s_lshl_b32 s43, s40, 8
  s_add_u32 s42, s42, s43
  buffer_load_dwordx4 v[60:63], v3, s[32:35], s42 offen nt
  s_add_u32 s42, s42, 36864
  buffer_load_dwordx4 v[64:67], v3, s[32:35], s42 offen nt
  s_add_u32 s42, s42, 36864
  buffer_load_dwordx4 v[68:71], v3, s[32:35], s42 offen nt
  s_add_u32 s42, s42, 36864
  buffer_load_dwordx4 v[72:75], v3, s[32:35], s42 offen nt
  s_add_u32 s42, s42, 36864
  buffer_load_dwordx4 v[76:79], v3, s[32:35], s42 offen nt
  s_add_u32 s42, s42, 36864
  buffer_load_dwordx4 v[80:83], v3, s[32:35], s42 offen nt
  s_add_u32 s42, s42, 36864
  buffer_load_dwordx4 v[84:87], v3, s[32:35], s42 offen nt
  s_add_u32 s42, s42, 36864
  buffer_load_dwordx4 v[88:91], v3, s[32:35], s42 offen nt
  s_add_u32 s42, s42, 36864
  buffer_load_dwordx4 v[92:95], v3, s[32:35], s42 offen nt
  s_add_u32 s42, s42, 36864
  buffer_load_dwordx4 v[96:99], v3, s[32:35], s42 offen nt
  s_add_u32 s42, s42, 36864
  buffer_load_dwordx4 v[100:103], v3, s[32:35], s42 offen nt
  s_add_u32 s42, s42, 36864
  buffer_load_dwordx4 v[104:107], v3, s[32:35], s42 offen nt
  s_add_u32 s42, s42, 36864
  buffer_load_dwordx4 v[108:111], v3, s[32:35], s42 offen nt
  s_add_u32 s42, s42, 36864
  buffer_load_dwordx4 v[112:115], v3, s[32:35], s42 offen nt
  s_add_u32 s42, s42, 36864
  buffer_load_dwordx4 v[116:119], v3, s[32:35], s42 offen nt
  s_add_u32 s42, s42, 36864
  buffer_load_dwordx4 v[120:123], v3, s[32:35], s42 offen nt
  s_add_u32 s42, s42, 36864
  buffer_load_dwordx4 v[124:127], v3, s[32:35], s42 offen nt
  s_add_u32 s42, s42, 36864
  buffer_load_dwordx4 v[128:131], v3, s[32:35], s42 offen nt
  s_add_u32 s42, s42, 36864
  buffer_load_dwordx4 v[132:135], v3, s[32:35], s42 offen nt
  s_add_u32 s42, s42, 36864
  buffer_load_dwordx4 v[136:139], v3, s[32:35], s42 offen nt
  s_add_u32 s42, s42, 36864
  buffer_load_dwordx4 v[140:143], v3, s[32:35], s42 offen nt
  s_add_u32 s42, s42, 36864
  buffer_load_dwordx4 v[144:147], v3, s[32:35], s42 offen nt
  s_add_u32 s42, s42, 36864
  buffer_load_dwordx4 v[148:151], v3, s[32:35], s42 offen nt
  s_add_u32 s42, s42, 36864
  buffer_load_dwordx4 v[152:155], v3, s[32:35], s42 offen nt
  s_mov_b32 s36, s18
  s_and_b32 s37, s19, 0xffff
  s_mov_b32 s38, 5308416
  s_mov_b32 s39, 0x20000
  v_lshrrev_b32 v5, 4, v0
  v_and_b32 v4, 15, v0
  v_mul_u32_u24 v6, 1152, v5
  v_lshl_add_u32 v6, v4, 4, v6
  v_bfrev_b32 v10, 1
  v_cmp_gt_u32 vcc, 8, v4
  s_nop 1
  v_cndmask_b32 v7, v10, v6, vcc
  v_cmp_gt_u32 vcc, 2, v5
  s_nop 1
  v_cndmask_b32 v8, v10, v6, vcc
  v_cndmask_b32 v9, v10, v7, vcc
  s_mul_i32 s42, s2, 20736
  buffer_load_dwordx4 v[156:159], v6, s[36:39], s42 offen offset:0 nt
  buffer_load_dwordx4 v[160:163], v6, s[36:39], s42 offen offset:256 nt
  buffer_load_dwordx4 v[164:167], v6, s[36:39], s42 offen offset:512 nt
  buffer_load_dwordx4 v[168:171], v6, s[36:39], s42 offen offset:768 nt
  buffer_load_dwordx4 v[172:175], v7, s[36:39], s42 offen offset:1024 nt
  s_add_u32 s42, s42, 4608
  buffer_load_dwordx4 v[176:179], v6, s[36:39], s42 offen offset:0 nt
  buffer_load_dwordx4 v[180:183], v6, s[36:39], s42 offen offset:256 nt
  buffer_load_dwordx4 v[184:187], v6, s[36:39], s42 offen offset:512 nt
  buffer_load_dwordx4 v[188:191], v6, s[36:39], s42 offen offset:768 nt
  buffer_load_dwordx4 v[192:195], v7, s[36:39], s42 offen offset:1024 nt
  s_add_u32 s42, s42, 4608
  buffer_load_dwordx4 v[196:199], v6, s[36:39], s42 offen offset:0 nt
  buffer_load_dwordx4 v[200:203], v6, s[36:39], s42 offen offset:256 nt
  buffer_load_dwordx4 v[204:207], v6, s[36:39], s42 offen offset:512 nt
  buffer_load_dwordx4 v[208:211], v6, s[36:39], s42 offen offset:768 nt
  buffer_load_dwordx4 v[212:215], v7, s[36:39], s42 offen offset:1024 nt
  s_add_u32 s42, s42, 4608
  buffer_load_dwordx4 v[216:219], v6, s[36:39], s42 offen offset:0 nt
  buffer_load_dwordx4 v[220:223], v6, s[36:39], s42 offen offset:256 nt
  buffer_load_dwordx4 v[224:227], v6, s[36:39], s42 offen offset:512 nt
  buffer_load_dwordx4 v[228:231], v6, s[36:39], s42 offen offset:768 nt
  buffer_load_dwordx4 v[232:235], v7, s[36:39], s42 offen offset:1024 nt
  s_add_u32 s42, s42, 4608
  buffer_load_dwordx4 v[236:239], v8, s[36:39], s42 offen offset:0 nt
  buffer_load_dwordx4 v[240:243], v8, s[36:39], s42 offen offset:256 nt
  buffer_load_dwordx4 v[244:247], v8, s[36:39], s42 offen offset:512 nt
  buffer_load_dwordx4 v[248:251], v8, s[36:39], s42 offen offset:768 nt
  buffer_load_dwordx4 v[252:255], v9, s[36:39], s42 offen offset:1024 nt
  s_waitcnt vmcnt(28)
  v_mov_b32 v2, 133272
  v_mov_b32 v3, 1
  ds_write_b32 v2, v3
  s_waitcnt lgkmcnt(0)
  s_add_u32 s24, s24, 1
  s_branch L_gatherwait
L_gatherwait:
  v_mov_b32 v2, 133128
  s_mov_b32 s43, 200000
L_gw:
  ds_read_b32 v3, v2
  s_waitcnt lgkmcnt(0)
  v_readfirstlane_b32 s44, v3
  s_cmp_lg_u32 s44, 0
  s_cbranch_scc1 L_gw_ok
  s_sub_u32 s43, s43, 1
  s_cbranch_scc1 L_gw_ok
  s_sleep 1
  s_branch L_gw
L_gw_ok:
L_gather:
  v_mov_b32 v2, 133272
  s_mov_b32 s43, 200000
L_gw2:
  ds_read_b32 v3, v2
  s_waitcnt lgkmcnt(0)
  v_readfirstlane_b32 s44, v3
  s_cmp_lg_u32 s44, 0
  s_cbranch_scc1 L_gw2_ok
  s_sub_u32 s43, s43, 1
  s_cbranch_scc1 L_gw2_ok
  s_sleep 1
  s_branch L_gw2
L_gw2_ok:
  s_lshl_b32 s42, s25, 2
  s_add_u32 s42, s42, s3
  s_sub_u32 s42, s42, 4
  s_lshl_b32 s42, s42, 11
  s_add_u32 s42, s42, 4096
  v_lshlrev_b32 v2, 3, v0
  buffer_load_dwordx2 v[24:25], v2, s[28:31], s42 offen offset:0 sc1
  buffer_load_dwordx2 v[26:27], v2, s[28:31], s42 offen offset:512 sc1
  buffer_load_dwordx2 v[28:29], v2, s[28:31], s42 offen offset:1024 sc1
  buffer_load_dwordx2 v[30:31], v2, s[28:31], s42 offen offset:1536 sc1
  s_sleep 6
  buffer_load_dwordx2 v[32:33], v2, s[28:31], s42 offen offset:0 sc1
  buffer_load_dwordx2 v[34:35], v2, s[28:31], s42 offen offset:512 sc1
  buffer_load_dwordx2 v[36:37], v2, s[28:31], s42 offen offset:1024 sc1
  buffer_load_dwordx2 v[38:39], v2, s[28:31], s42 offen offset:1536 sc1
  s_mov_b32 s43, 200000
L_gq_loop:
  s_waitcnt vmcnt(4)
  v_cmp_ne_u32 s[44:45], s24, v25
  v_cmp_ne_u32 s[46:47], s24, v27
  v_cmp_ne_u32 s[48:49], s24, v29
  v_cmp_ne_u32 s[50:51], s24, v31
  s_mov_b64 s[52:53], s[44:45]
  s_or_b64 s[52:53], s[52:53], s[46:47]
  s_or_b64 s[52:53], s[52:53], s[48:49]
  s_or_b64 s[52:53], s[52:53], s[50:51]
  s_cmp_eq_u64 s[52:53], 0
  s_cbranch_scc1 L_gq_A
  s_sleep 3
  s_or_b32 exec_lo, s44, 1
  s_mov_b32 exec_hi, s45
  buffer_load_dwordx2 v[24:25], v2, s[28:31], s42 offen offset:0 sc1
  s_or_b32 exec_lo, s46, 1
  s_mov_b32 exec_hi, s47
  buffer_load_dwordx2 v[26:27], v2, s[28:31], s42 offen offset:512 sc1
  s_or_b32 exec_lo, s48, 1
  s_mov_b32 exec_hi, s49
  buffer_load_dwordx2 v[28:29], v2, s[28:31], s42 offen offset:1024 sc1
  s_or_b32 exec_lo, s50, 1
  s_mov_b32 exec_hi, s51
  buffer_load_dwordx2 v[30:31], v2, s[28:31], s42 offen offset:1536 sc1
  s_mov_b64 exec, -1
  s_waitcnt vmcnt(4)
  v_cmp_ne_u32 s[44:45], s24, v33
  v_cmp_ne_u32 s[46:47], s24, v35
  v_cmp_ne_u32 s[48:49], s24, v37
  v_cmp_ne_u32 s[50:51], s24, v39
  s_mov_b64 s[52:53], s[44:45]
  s_or_b64 s[52:53], s[52:53], s[46:47]
  s_or_b64 s[52:53], s[52:53], s[48:49]
  s_or_b64 s[52:53], s[52:53], s[50:51]
  s_cmp_eq_u64 s[52:53], 0
  s_cbranch_scc1 L_gq_B
  s_sleep 3
  s_or_b32 exec_lo, s44, 1
  s_mov_b32 exec_hi, s45
  buffer_load_dwordx2 v[32:33], v2, s[28:31], s42 offen offset:0 sc1
  s_or_b32 exec_lo, s46, 1
  s_mov_b32 exec_hi, s47
  buffer_load_dwordx2 v[34:35], v2, s[28:31], s42 offen offset:512 sc1
  s_or_b32 exec_lo, s48, 1
  s_mov_b32 exec_hi, s49
  buffer_load_dwordx2 v[36:37], v2, s[28:31], s42 offen offset:1024 sc1
  s_or_b32 exec_lo, s50, 1
  s_mov_b32 exec_hi, s51
  buffer_load_dwordx2 v[38:39], v2, s[28:31], s42 offen offset:1536 sc1
  s_mov_b64 exec, -1
  s_sub_u32 s43, s43, 1
  s_cbranch_scc0 L_gq_loop
L_gq_A:
  v_add_f32 v8, v24, v26
  v_add_f32 v8, v8, v28
  v_add_f32 v8, v8, v30
  s_branch L_gq_done
L_gq_B:
  v_add_f32 v8, v32, v34
  v_add_f32 v8, v8, v36
  v_add_f32 v8, v8, v38
L_gq_done:
  v_cvt_pk_bf16_f32 v8, v8, v8
  s_sub_u32 s42, s3, 4
  s_lshl_b32 s42, s42, 7
  s_add_u32 s42, s42, 132352
  v_lshlrev_b32 v2, 1, v0
  v_add_u32 v2, s42, v2
  ds_write_b16 v2, v8
  s_waitcnt lgkmcnt(0)
  s_sub_u32 s42, s3, 4
  s_lshl_b32 s42, s42, 2
  s_add_u32 s42, s42, 133248
  v_mov_b32 v2, s42
  v_mov_b32 v3, 1
  ds_write_b32 v2, v3
  s_waitcnt vmcnt(0)
  s_cmp_eq_u32 s3, 4
  s_cbranch_scc1 L_w4b
  s_cmp_eq_u32 s3, 5
  s_cbranch_scc1 L_ffn2
  s_cmp_eq_u32 s3, 6
  s_cbranch_scc1 L_w6
  s_endpgm
L_w6:
  v_mov_b32 v2, 133120
  s_mov_b32 s43, 200000
L_w6poll:
  ds_read_b32 v3, v2
  s_waitcnt lgkmcnt(0)
  v_readfirstlane_b32 s44, v3
  s_cmp_ge_u32 s44, 49
  s_cbranch_scc1 L_w6go
  s_sub_u32 s43, s43, 1
  s_cbranch_scc1 L_w6go
  s_sleep 16
  s_branch L_w6poll
L_w6go:
  s_getpc_b64 s[32:33]
L_pc6:
  s_sub_u32 s32, s32, L_pc6-parallel_sum__gqa_block_cached__dense_activation_silu__decode_kernel
  s_subb_u32 s33, s33, 0
  s_and_b32 s33, s33, 0xffff
  s_mov_b32 s34, L_codeend-parallel_sum__gqa_block_cached__dense_activation_silu__decode_kernel
  s_mov_b32 s35, 0x20000
  v_lshlrev_b32 v2, 4, v0
  s_lshr_b32 s36, s2, 3
  s_lshl_b32 s36, s36, 10
  v_add_u32 v2, s36, v2
  buffer_load_dwordx4 v[4:7], v2, s[32:35], 0 offen
  s_mul_i32 s36, s25, 1
  s_lshr_b32 s37, s26, 4
  s_add_u32 s36, s36, s37
  s_mul_i32 s36, s36, 4096
  s_add_u32 s36, s36, 5636096
  v_mov_b32 v2, 0
  s_mov_b32 s43, 200000
L_cntpoll:
  buffer_load_dwordx2 v[8:9], v2, s[28:31], s36 offen sc1
  s_waitcnt vmcnt(0)
  v_readfirstlane_b32 s44, v9
  s_cmp_eq_u32 s44, s24
  s_cbranch_scc1 L_cntok
  s_sub_u32 s43, s43, 1
  s_cbranch_scc1 L_cntok
  s_sleep 8
  s_branch L_cntpoll
L_cntok:
  v_lshrrev_b32 v3, 2, v0
  v_and_b32 v14, 3, v0
  v_lshlrev_b32 v4, 2, v3
  v_add_u32 v4, 133136, v4
  v_lshlrev_b32 v12, 4, v3
  v_add_u32 v12, 133152, v12
  v_mov_b32 v5, 58
  v_mov_b32 v6, 0
  s_mov_b64 exec, 255
  s_mov_b32 s43, 800000
L_srv:
  ds_read_b32 v7, v4
  s_waitcnt lgkmcnt(0)
  v_sub_u32 v13, v7, v5
  v_cmp_lt_i32 vcc, 0, v13
  s_cmp_eq_u64 vcc, 0
  s_cbranch_scc1 L_srvidle
  s_and_b64 exec, vcc, 0x11
  v_mov_b32 v10, v13
  buffer_atomic_add v10, v2, s[28:31], s36 offen sc0 sc1
  s_mov_b64 exec, vcc
  v_add3_u32 v11, v5, v14, 1
  v_and_b32 v15, 3, v11
  v_lshl_add_u32 v15, v15, 2, v12
  v_cmp_lt_u32 s[46:47], v14, v13
  v_add_u32 v5, v5, v13
  s_waitcnt vmcnt(0)
  s_nop 1
  v_mov_b32_dpp v10, v10 quad_perm:[0,0,0,0] row_mask:0xf bank_mask:0xf
  s_nop 1
  v_add_u32 v16, v10, v13
  v_add_u32 v10, v10, v14
  v_min_u32 v10, 0xffff, v10
  v_lshl_or_b32 v11, v11, 16, v10
  v_cmp_lt_u32 vcc, 160, v16
  s_nop 1
  v_cndmask_b32 v6, v6, 1, vcc
  s_mov_b64 exec, s[46:47]
  ds_write_b32 v15, v11
  s_mov_b64 exec, 255
  v_cmp_eq_u32 vcc, 1, v6
  s_cmp_eq_u64 vcc, 255
  s_cbranch_scc1 L_srvend
  s_branch L_srv
L_srvidle:
  s_sub_u32 s43, s43, 1
  s_cbranch_scc1 L_srvend
  s_sleep 1
  s_branch L_srv
L_srvend:
  s_waitcnt lgkmcnt(0)
  s_endpgm
L_ffn2:
  v_bfe_u32 v31, v0, 1, 2
  v_bfe_u32 v30, v0, 3, 1
  v_lshl_or_b32 v31, v30, 2, v31
  v_and_b32 v30, 1, v0
  v_mov_b32 v28, 0xc0c0100
  v_mov_b32 v29, 0x1000c0c
  v_cmp_eq_u32 vcc, 1, v30
  s_nop 1
  v_cndmask_b32 v28, v28, v29, vcc
  v_mov_b32 v29, 0x0c0c0c0c
  v_cmp_eq_u32 vcc, 0, v31
  s_nop 1
  v_cndmask_b32 v16, v29, v28, vcc
  v_cmp_eq_u32 vcc, 1, v31
  s_nop 1
  v_cndmask_b32 v17, v29, v28, vcc
  v_cmp_eq_u32 vcc, 2, v31
  s_nop 1
  v_cndmask_b32 v18, v29, v28, vcc
  v_cmp_eq_u32 vcc, 3, v31
  s_nop 1
  v_cndmask_b32 v19, v29, v28, vcc
  v_mov_b32 v28, 0xc0c0302
  v_mov_b32 v29, 0x3020c0c
  v_cmp_eq_u32 vcc, 1, v30
  s_nop 1
  v_cndmask_b32 v28, v28, v29, vcc
  v_mov_b32 v29, 0x0c0c0c0c
  v_cmp_eq_u32 vcc, 0, v31
  s_nop 1
  v_cndmask_b32 v20, v29, v28, vcc
  v_cmp_eq_u32 vcc, 1, v31
  s_nop 1
  v_cndmask_b32 v21, v29, v28, vcc
  v_cmp_eq_u32 vcc, 2, v31
  s_nop 1
  v_cndmask_b32 v22, v29, v28, vcc
  v_cmp_eq_u32 vcc, 3, v31
  s_nop 1
  v_cndmask_b32 v23, v29, v28, vcc
  v_mov_b32 v2, 133124
  s_mov_b32 s43, 200000
L_f0w:
  ds_read_b32 v3, v2
  s_waitcnt lgkmcnt(0)
  v_readfirstlane_b32 s44, v3
  s_cmp_lg_u32 s44, 0
  s_cbranch_scc1 L_f0w_ok
  s_sub_u32 s43, s43, 1
  s_cbranch_scc1 L_f0w_ok
  s_sleep 1
  s_branch L_f0w
L_f0w_ok:
  s_mul_i32 s42, s41, 192
  s_add_u32 s42, s42, 131072
  v_lshrrev_b32 v2, 4, v0
  v_lshlrev_b32 v2, 1, v2
  v_add_u32 v2, s42, v2
  s_cmp_ge_u32 s2, 216
  s_cbranch_scc1 L_ffn_h
  ds_read_u16 v32, v2 offset:0
  ds_read_u16 v33, v2 offset:8
  ds_read_u16 v34, v2 offset:16
  ds_read_u16 v35, v2 offset:24
  ds_read_u16 v36, v2 offset:32
  ds_read_u16 v37, v2 offset:40
  ds_read_u16 v38, v2 offset:48
  ds_read_u16 v39, v2 offset:56
  ds_read_u16 v40, v2 offset:64
  ds_read_u16 v41, v2 offset:72
  ds_read_u16 v42, v2 offset:80
  ds_read_u16 v43, v2 offset:88
  ds_read_u16 v44, v2 offset:96
  ds_read_u16 v45, v2 offset:104
  ds_read_u16 v46, v2 offset:112
  ds_read_u16 v47, v2 offset:120
  ds_read_u16 v48, v2 offset:128
  ds_read_u16 v49, v2 offset:136
  ds_read_u16 v50, v2 offset:144
  ds_read_u16 v51, v2 offset:152
  ds_read_u16 v52, v2 offset:160
  ds_read_u16 v53, v2 offset:168
  ds_read_u16 v54, v2 offset:176
  ds_read_u16 v55, v2 offset:184
  s_waitcnt vmcnt(0) lgkmcnt(0)
  v_perm_b32 v8, v32, v32, v16
  v_perm_b32 v9, v32, v32, v17
  v_perm_b32 v10, v32, v32, v18
  v_perm_b32 v11, v32, v32, v19
  s_nop 0
  v_mfma_f32_16x16x32_bf16 v[24:27], v[8:11], v[60:63], 0
  v_perm_b32 v12, v33, v33, v16
  v_perm_b32 v13, v33, v33, v17
  v_perm_b32 v14, v33, v33, v18
  v_perm_b32 v15, v33, v33, v19
  s_nop 0
  v_mfma_f32_16x16x32_bf16 v[24:27], v[12:15], v[64:67], v[24:27]
  v_perm_b32 v8, v34, v34, v16
  v_perm_b32 v9, v34, v34, v17
  v_perm_b32 v10, v34, v34, v18
  v_perm_b32 v11, v34, v34, v19
  s_nop 0
  v_mfma_f32_16x16x32_bf16 v[24:27], v[8:11], v[68:71], v[24:27]
  v_perm_b32 v12, v35, v35, v16
  v_perm_b32 v13, v35, v35, v17
  v_perm_b32 v14, v35, v35, v18
  v_perm_b32 v15, v35, v35, v19
  s_nop 0
  v_mfma_f32_16x16x32_bf16 v[24:27], v[12:15], v[72:75], v[24:27]
  v_perm_b32 v8, v36, v36, v16
  v_perm_b32 v9, v36, v36, v17
  v_perm_b32 v10, v36, v36, v18
  v_perm_b32 v11, v36, v36, v19
  s_nop 0
  v_mfma_f32_16x16x32_bf16 v[24:27], v[8:11], v[76:79], v[24:27]
  v_perm_b32 v12, v37, v37, v16
  v_perm_b32 v13, v37, v37, v17
  v_perm_b32 v14, v37, v37, v18
  v_perm_b32 v15, v37, v37, v19
  s_nop 0
  v_mfma_f32_16x16x32_bf16 v[24:27], v[12:15], v[80:83], v[24:27]
  v_perm_b32 v8, v38, v38, v16
  v_perm_b32 v9, v38, v38, v17
  v_perm_b32 v10, v38, v38, v18
  v_perm_b32 v11, v38, v38, v19
  s_nop 0
  v_mfma_f32_16x16x32_bf16 v[24:27], v[8:11], v[84:87], v[24:27]
  v_perm_b32 v12, v39, v39, v16
  v_perm_b32 v13, v39, v39, v17
  v_perm_b32 v14, v39, v39, v18
  v_perm_b32 v15, v39, v39, v19
  s_nop 0
  v_mfma_f32_16x16x32_bf16 v[24:27], v[12:15], v[88:91], v[24:27]
  v_perm_b32 v8, v40, v40, v16
  v_perm_b32 v9, v40, v40, v17
  v_perm_b32 v10, v40, v40, v18
  v_perm_b32 v11, v40, v40, v19
  s_nop 0
  v_mfma_f32_16x16x32_bf16 v[24:27], v[8:11], v[92:95], v[24:27]
  v_perm_b32 v12, v41, v41, v16
  v_perm_b32 v13, v41, v41, v17
  v_perm_b32 v14, v41, v41, v18
  v_perm_b32 v15, v41, v41, v19
  s_nop 0
  v_mfma_f32_16x16x32_bf16 v[24:27], v[12:15], v[96:99], v[24:27]
  v_perm_b32 v8, v42, v42, v16
  v_perm_b32 v9, v42, v42, v17
  v_perm_b32 v10, v42, v42, v18
  v_perm_b32 v11, v42, v42, v19
  s_nop 0
  v_mfma_f32_16x16x32_bf16 v[24:27], v[8:11], v[100:103], v[24:27]
  v_perm_b32 v12, v43, v43, v16
  v_perm_b32 v13, v43, v43, v17
  v_perm_b32 v14, v43, v43, v18
  v_perm_b32 v15, v43, v43, v19
  s_nop 0
  v_mfma_f32_16x16x32_bf16 v[24:27], v[12:15], v[104:107], v[24:27]
  v_perm_b32 v8, v44, v44, v16
  v_perm_b32 v9, v44, v44, v17
  v_perm_b32 v10, v44, v44, v18
  v_perm_b32 v11, v44, v44, v19
  s_nop 0
  v_mfma_f32_16x16x32_bf16 v[24:27], v[8:11], v[108:111], v[24:27]
  v_perm_b32 v12, v45, v45, v16
  v_perm_b32 v13, v45, v45, v17
  v_perm_b32 v14, v45, v45, v18
  v_perm_b32 v15, v45, v45, v19
  s_nop 0
  v_mfma_f32_16x16x32_bf16 v[24:27], v[12:15], v[112:115], v[24:27]
  v_perm_b32 v8, v46, v46, v16
  v_perm_b32 v9, v46, v46, v17
  v_perm_b32 v10, v46, v46, v18
  v_perm_b32 v11, v46, v46, v19
  s_nop 0
  v_mfma_f32_16x16x32_bf16 v[24:27], v[8:11], v[116:119], v[24:27]
  v_perm_b32 v12, v47, v47, v16
  v_perm_b32 v13, v47, v47, v17
  v_perm_b32 v14, v47, v47, v18
  v_perm_b32 v15, v47, v47, v19
  s_nop 0
  v_mfma_f32_16x16x32_bf16 v[24:27], v[12:15], v[120:123], v[24:27]
  v_perm_b32 v8, v48, v48, v16
  v_perm_b32 v9, v48, v48, v17
  v_perm_b32 v10, v48, v48, v18
  v_perm_b32 v11, v48, v48, v19
  s_nop 0
  v_mfma_f32_16x16x32_bf16 v[24:27], v[8:11], v[124:127], v[24:27]
  v_perm_b32 v12, v49, v49, v16
  v_perm_b32 v13, v49, v49, v17
  v_perm_b32 v14, v49, v49, v18
  v_perm_b32 v15, v49, v49, v19
  s_nop 0
  v_mfma_f32_16x16x32_bf16 v[24:27], v[12:15], v[128:131], v[24:27]
  v_perm_b32 v8, v50, v50, v16
  v_perm_b32 v9, v50, v50, v17
  v_perm_b32 v10, v50, v50, v18
  v_perm_b32 v11, v50, v50, v19
  s_nop 0
  v_mfma_f32_16x16x32_bf16 v[24:27], v[8:11], v[132:135], v[24:27]
  v_perm_b32 v12, v51, v51, v16
  v_perm_b32 v13, v51, v51, v17
  v_perm_b32 v14, v51, v51, v18
  v_perm_b32 v15, v51, v51, v19
  s_nop 0
  v_mfma_f32_16x16x32_bf16 v[24:27], v[12:15], v[136:139], v[24:27]
  v_perm_b32 v8, v52, v52, v16
  v_perm_b32 v9, v52, v52, v17
  v_perm_b32 v10, v52, v52, v18
  v_perm_b32 v11, v52, v52, v19
  s_nop 0
  v_mfma_f32_16x16x32_bf16 v[24:27], v[8:11], v[140:143], v[24:27]
  v_perm_b32 v12, v53, v53, v16
  v_perm_b32 v13, v53, v53, v17
  v_perm_b32 v14, v53, v53, v18
  v_perm_b32 v15, v53, v53, v19
  s_nop 0
  v_mfma_f32_16x16x32_bf16 v[24:27], v[12:15], v[144:147], v[24:27]
  v_perm_b32 v8, v54, v54, v16
  v_perm_b32 v9, v54, v54, v17
  v_perm_b32 v10, v54, v54, v18
  v_perm_b32 v11, v54, v54, v19
  s_nop 0
  v_mfma_f32_16x16x32_bf16 v[24:27], v[8:11], v[148:151], v[24:27]
  v_perm_b32 v12, v55, v55, v16
  v_perm_b32 v13, v55, v55, v17
  v_perm_b32 v14, v55, v55, v18
  v_perm_b32 v15, v55, v55, v19
  s_nop 0
  v_mfma_f32_16x16x32_bf16 v[24:27], v[12:15], v[152:155], v[24:27]
  v_and_b32 v8, 15, v0
  v_lshlrev_b32 v8, 6, v8
  v_bfe_u32 v6, v0, 4, 1
  v_lshl_add_u32 v8, v6, 5, v8
  v_lshrrev_b32 v6, 5, v0
  v_lshl_add_u32 v8, v6, 4, v8
  s_mul_i32 s42, s40, 6
  s_add_u32 s42, s42, s41
  s_lshl_b32 s42, s42, 10
  s_add_u32 s42, s42, 327680
  s_nop 7
  v_permlane32_swap_b32 v24, v26
  v_permlane32_swap_b32 v25, v27
  s_nop 0
  v_mov_b32 v48, v24
  v_mov_b32 v49, s24
  v_mov_b32 v50, v25
  v_mov_b32 v51, s24
  buffer_store_dwordx4 v[48:51], v8, s[28:31], s42 offen sc1
L_ffn_h:
  v_mov_b32 v2, 133120
  s_mov_b32 s43, 200000
L_hw:
  ds_read_b32 v3, v2
  s_waitcnt lgkmcnt(0)
  v_readfirstlane_b32 s44, v3
  s_cmp_ge_u32 s44, 6
  s_cbranch_scc1 L_hwgo
  s_sub_u32 s43, s43, 1
  s_cbranch_scc1 L_hwgo
  s_sleep 16
  s_branch L_hw
L_hwgo:
  s_mul_i32 s42, s2, 18
  v_min_u32 v2, 17, v0
  v_add_u32 v2, s42, v2
  v_lshrrev_b32 v3, 7, v2
  v_mul_u32_u24 v3, 6144, v3
  v_and_b32 v2, 127, v2
  v_lshl_add_u32 v2, v2, 3, v3
  s_mov_b32 s42, 327680
  s_mov_b32 s44, 331776
  s_mov_b32 s43, 200000
L_hpoll:
  buffer_load_dwordx2 v[32:33], v2, s[28:31], s42 offen offset:0 sc1
  buffer_load_dwordx2 v[34:35], v2, s[28:31], s42 offen offset:1024 sc1
  buffer_load_dwordx2 v[36:37], v2, s[28:31], s42 offen offset:2048 sc1
  buffer_load_dwordx2 v[38:39], v2, s[28:31], s42 offen offset:3072 sc1
  buffer_load_dwordx2 v[40:41], v2, s[28:31], s44 offen offset:0 sc1
  buffer_load_dwordx2 v[42:43], v2, s[28:31], s44 offen offset:1024 sc1
  s_waitcnt vmcnt(0)
  v_min_u32 v46, v33, v35
  v_max_u32 v47, v33, v35
  v_min3_u32 v46, v46, v37, v39
  v_max3_u32 v47, v47, v37, v39
  v_min3_u32 v46, v46, v41, v43
  v_max3_u32 v47, v47, v41, v43
  v_cmp_eq_u32 vcc, s24, v46
  v_cmp_eq_u32 s[46:47], s24, v47
  s_and_b64 vcc, vcc, s[46:47]
  s_cmp_eq_u64 vcc, -1
  s_cbranch_scc1 L_hdone
  s_sub_u32 s43, s43, 1
  s_cbranch_scc1 L_hdone
  s_sleep 16
  s_branch L_hpoll
L_hdone:
  v_add_f32 v24, v32, v34
  v_add_f32 v24, v24, v36
  v_add_f32 v24, v24, v38
  v_add_f32 v24, v24, v40
  v_add_f32 v24, v24, v42
  v_cvt_pk_bf16_f32 v48, v24, v24
  v_lshlrev_b32 v24, 16, v48
  v_mul_f32 v52, 0xbfb8aa3b, v24
  v_exp_f32 v52, v52
  s_nop 0
  v_add_f32 v52, 1.0, v52
  v_min_f32 v52, 0x7e967699, v52
  v_rcp_f32 v56, v52
  s_nop 0
  v_fma_f32 v57, -v52, v56, 1.0
  v_fma_f32 v56, v57, v56, v56
  v_mul_f32 v58, v24, v56
  v_fma_f32 v57, -v58, v52, v24
  v_fma_f32 v58, v57, v56, v58
  v_cvt_pk_bf16_f32 v48, v58, v58
  v_cmp_gt_u32 vcc, 18, v0
  s_nop 1
  v_cndmask_b32 v48, 0, v48, vcc
  v_lshlrev_b32 v2, 1, v0
  v_add_u32 v2, 132864, v2
  s_mov_b64 exec, 0xfffff
  ds_write_b16 v2, v48
  s_mov_b64 exec, -1
  s_waitcnt lgkmcnt(0)
  v_lshrrev_b32 v2, 4, v0
  v_lshlrev_b32 v2, 1, v2
  v_add_u32 v2, 132864, v2
  ds_read_u16 v32, v2 offset:0
  ds_read_u16 v33, v2 offset:8
  ds_read_u16 v34, v2 offset:16
  ds_read_u16 v35, v2 offset:24
  ds_read_u16 v36, v2 offset:32
  s_waitcnt vmcnt(0) lgkmcnt(0)
  v_perm_b32 v8, v32, v32, v16
  v_perm_b32 v9, v32, v32, v17
  v_perm_b32 v10, v32, v32, v18
  v_perm_b32 v11, v32, v32, v19
  s_nop 0
  v_mfma_f32_16x16x32_bf16 v[60:63], v[8:11], v[156:159], 0
  v_mfma_f32_16x16x32_bf16 v[64:67], v[8:11], v[160:163], 0
  v_mfma_f32_16x16x32_bf16 v[68:71], v[8:11], v[164:167], 0
  v_mfma_f32_16x16x32_bf16 v[72:75], v[8:11], v[168:171], 0
  v_mfma_f32_16x16x32_bf16 v[76:79], v[8:11], v[172:175], 0
  v_perm_b32 v12, v33, v33, v16
  v_perm_b32 v13, v33, v33, v17
  v_perm_b32 v14, v33, v33, v18
  v_perm_b32 v15, v33, v33, v19
  s_nop 0
  v_mfma_f32_16x16x32_bf16 v[60:63], v[12:15], v[176:179], v[60:63]
  v_mfma_f32_16x16x32_bf16 v[64:67], v[12:15], v[180:183], v[64:67]
  v_mfma_f32_16x16x32_bf16 v[68:71], v[12:15], v[184:187], v[68:71]
  v_mfma_f32_16x16x32_bf16 v[72:75], v[12:15], v[188:191], v[72:75]
  v_mfma_f32_16x16x32_bf16 v[76:79], v[12:15], v[192:195], v[76:79]
  v_perm_b32 v8, v34, v34, v16
  v_perm_b32 v9, v34, v34, v17
  v_perm_b32 v10, v34, v34, v18
  v_perm_b32 v11, v34, v34, v19
  s_nop 0
  v_mfma_f32_16x16x32_bf16 v[60:63], v[8:11], v[196:199], v[60:63]
  v_mfma_f32_16x16x32_bf16 v[64:67], v[8:11], v[200:203], v[64:67]
  v_mfma_f32_16x16x32_bf16 v[68:71], v[8:11], v[204:207], v[68:71]
  v_mfma_f32_16x16x32_bf16 v[72:75], v[8:11], v[208:211], v[72:75]
  v_mfma_f32_16x16x32_bf16 v[76:79], v[8:11], v[212:215], v[76:79]
  v_perm_b32 v12, v35, v35, v16
  v_perm_b32 v13, v35, v35, v17
  v_perm_b32 v14, v35, v35, v18
  v_perm_b32 v15, v35, v35, v19
  s_nop 0
  v_mfma_f32_16x16x32_bf16 v[60:63], v[12:15], v[216:219], v[60:63]
  v_mfma_f32_16x16x32_bf16 v[64:67], v[12:15], v[220:223], v[64:67]
  v_mfma_f32_16x16x32_bf16 v[68:71], v[12:15], v[224:227], v[68:71]
  v_mfma_f32_16x16x32_bf16 v[72:75], v[12:15], v[228:231], v[72:75]
  v_mfma_f32_16x16x32_bf16 v[76:79], v[12:15], v[232:235], v[76:79]
  v_perm_b32 v8, v36, v36, v16
  v_perm_b32 v9, v36, v36, v17
  v_perm_b32 v10, v36, v36, v18
  v_perm_b32 v11, v36, v36, v19
  s_nop 0
  v_mfma_f32_16x16x32_bf16 v[60:63], v[8:11], v[236:239], v[60:63]
  v_mfma_f32_16x16x32_bf16 v[64:67], v[8:11], v[240:243], v[64:67]
  v_mfma_f32_16x16x32_bf16 v[68:71], v[8:11], v[244:247], v[68:71]
  v_mfma_f32_16x16x32_bf16 v[72:75], v[8:11], v[248:251], v[72:75]
  v_mfma_f32_16x16x32_bf16 v[76:79], v[8:11], v[252:255], v[76:79]
  v_lshlrev_b32 v2, 4, v0
  v_add_u32 v2, 138240, v2
  s_nop 7
  s_nop 7
  ds_write_b128 v2, v[60:63] offset:0
  ds_write_b128 v2, v[64:67] offset:1024
  ds_write_b128 v2, v[68:71] offset:2048
  ds_write_b128 v2, v[72:75] offset:3072
  ds_write_b128 v2, v[76:79] offset:4096
  v_mov_b32 v6, 133268
  v_mov_b32 v7, 1
  ds_write_b32 v6, v7
  s_waitcnt lgkmcnt(0)
L_ffn_end:
  s_endpgm
L_w4b:
  s_mov_b32 s32, s12
  s_and_b32 s33, s13, 0xffff
  s_mov_b32 s34, 4718592
  s_mov_b32 s35, 0x20000
  s_lshl_b32 s40, s25, 8
  s_lshl_b32 s41, s26, 4
  s_add_u32 s40, s40, s41
  s_mul_i32 s40, s40, 1152
  v_lshrrev_b32 v3, 4, v0
  v_mul_u32_u24 v3, 4608, v3
  v_and_b32 v4, 15, v0
  v_lshl_add_u32 v3, v4, 4, v3
  v_cmp_gt_u32 vcc, 8, v4
  v_bfrev_b32 v5, 1
  s_nop 0
  v_cndmask_b32 v4, v5, v3, vcc
  s_mov_b32 s53, s40
  v_bfe_u32 v31, v0, 1, 2
  v_bfe_u32 v30, v0, 3, 1
  v_lshl_or_b32 v31, v30, 2, v31
  v_and_b32 v30, 1, v0
  v_mov_b32 v28, 0xc0c0100
  v_mov_b32 v29, 0x1000c0c
  v_cmp_eq_u32 vcc, 1, v30
  s_nop 1
  v_cndmask_b32 v28, v28, v29, vcc
  v_mov_b32 v29, 0x0c0c0c0c
  v_cmp_eq_u32 vcc, 0, v31
  s_nop 1
  v_cndmask_b32 v16, v29, v28, vcc
  v_cmp_eq_u32 vcc, 1, v31
  s_nop 1
  v_cndmask_b32 v17, v29, v28, vcc
  v_cmp_eq_u32 vcc, 2, v31
  s_nop 1
  v_cndmask_b32 v18, v29, v28, vcc
  v_cmp_eq_u32 vcc, 3, v31
  s_nop 1
  v_cndmask_b32 v19, v29, v28, vcc
  v_mov_b32 v28, 0xc0c0302
  v_mov_b32 v29, 0x3020c0c
  v_cmp_eq_u32 vcc, 1, v30
  s_nop 1
  v_cndmask_b32 v28, v28, v29, vcc
  v_mov_b32 v29, 0x0c0c0c0c
  v_cmp_eq_u32 vcc, 0, v31
  s_nop 1
  v_cndmask_b32 v20, v29, v28, vcc
  v_cmp_eq_u32 vcc, 1, v31
  s_nop 1
  v_cndmask_b32 v21, v29, v28, vcc
  v_cmp_eq_u32 vcc, 2, v31
  s_nop 1
  v_cndmask_b32 v22, v29, v28, vcc
  v_cmp_eq_u32 vcc, 3, v31
  s_nop 1
  v_cndmask_b32 v23, v29, v28, vcc
  s_lshl_b32 s41, s25, 1
  s_lshr_b32 s42, s26, 3
  s_add_u32 s41, s41, s42
  s_lshl_b32 s41, s41, 8
  s_add_u32 s41, s41, 262144
  v_and_b32 v6, 15, v0
  v_lshlrev_b32 v6, 4, v6
  v_add_u32 v6, s41, v6
  s_lshl_b32 s41, s25, 4
  s_add_u32 s41, s41, s26
  s_lshl_b32 s41, s41, 11
  s_add_u32 s41, s41, 1048576
  v_and_b32 v7, 15, v0
  v_lshlrev_b32 v7, 7, v7
  v_lshrrev_b32 v24, 4, v0
  v_lshl_add_u32 v7, v24, 4, v7
  v_add_u32 v7, s41, v7
  v_lshrrev_b32 v24, 5, v0
  v_lshlrev_b32 v24, 3, v24
  v_bfe_u32 v25, v0, 1, 3
  v_add_u32 v24, v24, v25
  v_lshlrev_b32 v24, 11, v24
  v_and_b32 v25, 1, v0
  v_lshlrev_b32 v25, 5, v25
  v_bfe_u32 v26, v0, 4, 1
  v_lshl_add_u32 v25, v26, 4, v25
  v_add_u32 v24, v24, v25
  s_lshl_b32 s41, s25, 15
  s_lshl_b32 s42, s26, 7
  s_add_u32 s41, s41, s42
  s_add_u32 s41, s41, 1048576
  v_add_u32 v10, s41, v24
  v_lshrrev_b32 v24, 5, v0
  v_lshlrev_b32 v24, 8, v24
  s_lshl_b32 s41, s25, 9
  s_lshl_b32 s42, s26, 4
  s_add_u32 s41, s41, s42
  s_add_u32 s41, s41, 262144
  v_add_u32 v11, s41, v24
  v_lshlrev_b32 v15, 4, v0
  v_add_u32 v15, 133376, v15
  v_and_b32 v8, 15, v0
  v_lshlrev_b32 v8, 6, v8
  v_bfe_u32 v24, v0, 4, 1
  v_lshl_add_u32 v8, v24, 5, v8
  v_lshrrev_b32 v24, 5, v0
  v_lshl_add_u32 v8, v24, 4, v8
  s_mul_i32 s41, s2, 4608
  s_add_u32 s41, s41, 4194304
  v_add_u32 v8, s41, v8
  s_sub_u32 s50, s2, 184
  v_and_b32 v24, 3, v0
  v_lshlrev_b32 v24, 2, v24
  s_lshl_b32 s51, s50, 4
  v_add_u32 v24, s51, v24
  v_mov_b32 v9, v24
  v_lshrrev_b32 v25, 2, v0
  v_mul_u32_u24 v25, 4608, v25
  v_and_b32 v26, 3, v0
  v_lshl_add_u32 v25, v26, 4, v25
  s_lshl_b32 s51, s50, 6
  v_add_u32 v25, s51, v25
  s_cmp_lt_u32 s2, 184
  s_cbranch_scc1 L_nofin1
  s_mov_b32 s36, s4
  s_and_b32 s37, s5, 0xffff
  s_mov_b32 s38, 1152
  s_mov_b32 s39, 0x20000
  buffer_load_dword v14, v24, s[36:39], 0 offen
L_nofin1:
  s_mov_b32 s36, s20
  s_and_b32 s37, s21, 0xffff
  s_mov_b32 s38, 1152
  s_mov_b32 s39, 0x20000
  v_mov_b32 v26, 133268
  s_mov_b32 s43, 200000
L_bfw:
  ds_read_b32 v27, v26
  s_waitcnt lgkmcnt(0)
  v_readfirstlane_b32 s44, v27
  s_cmp_lg_u32 s44, 0
  s_cbranch_scc1 L_bfok
  s_sub_u32 s43, s43, 1
  s_cbranch_scc1 L_bfok
  s_sleep 8
  s_branch L_bfw
L_bfok:
  v_lshlrev_b32 v26, 4, v0
  v_add_u32 v26, 138240, v26
  ds_read_b128 v[200:203], v26 offset:0
  ds_read_b128 v[204:207], v26 offset:1024
  ds_read_b128 v[208:211], v26 offset:2048
  ds_read_b128 v[212:215], v26 offset:3072
  ds_read_b128 v[216:219], v26 offset:4096
  s_waitcnt lgkmcnt(0)
  s_mov_b32 s46, 0
  s_mov_b32 s47, -1
  s_barrier
L_tail:
  ds_read_b128 v[160:163], v15 offset:0
  ds_read_b128 v[164:167], v15 offset:1152
  v_mov_b32 v24, 133376
  ds_read_b128 v[176:179], v24 offset:1024
  ds_read_b128 v[180:183], v24 offset:2176
  s_waitcnt lgkmcnt(0)
  v_cndmask_b32 v28, v176, v177, s[46:47]
  v_cndmask_b32 v32, v178, v179, s[46:47]
  v_cndmask_b32 v29, v180, v181, s[46:47]
  v_cndmask_b32 v33, v182, v183, s[46:47]
  v_max_f32 v36, v28, v29
  v_sub_f32 v28, v28, v36
  v_sub_f32 v29, v29, v36
  v_mul_f32 v28, 0x3fb8aa3b, v28
  v_mul_f32 v29, 0x3fb8aa3b, v29
  v_exp_f32 v28, v28
  v_exp_f32 v29, v29
  s_nop 0
  v_mul_f32 v40, v28, v160
  v_fma_f32 v40, v29, v164, v40
  v_mov_b32 v41, s24
  v_mul_f32 v42, v28, v161
  v_fma_f32 v42, v29, v165, v42
  v_mov_b32 v43, s24
  v_mul_f32 v44, v28, v162
  v_fma_f32 v44, v29, v166, v44
  v_mov_b32 v45, s24
  v_mul_f32 v46, v28, v163
  v_fma_f32 v46, v29, v167, v46
  v_mov_b32 v47, s24
  buffer_store_dwordx4 v[40:43], v10, s[28:31], 0 offen sc1
  buffer_store_dwordx4 v[44:47], v10, s[28:31], 0 offen offset:64 sc1
  v_mul_f32 v50, v28, v32
  v_fma_f32 v50, v29, v33, v50
  v_mov_b32 v48, v36
  v_mov_b32 v49, s24
  v_mov_b32 v51, s24
  s_mov_b32 exec_lo, 1
  s_mov_b32 exec_hi, 1
  buffer_store_dwordx4 v[48:51], v11, s[28:31], 0 offen sc1
  s_mov_b64 exec, -1
  buffer_load_dwordx4 v[64:67], v3, s[32:35], s53 offen offset:0 nt
  buffer_load_dwordx4 v[68:71], v3, s[32:35], s53 offen offset:256 nt
  buffer_load_dwordx4 v[72:75], v3, s[32:35], s53 offen offset:512 nt
  buffer_load_dwordx4 v[76:79], v3, s[32:35], s53 offen offset:768 nt
  buffer_load_dwordx4 v[80:83], v4, s[32:35], s53 offen offset:1024 nt
  s_add_u32 s53, s53, 1152
  buffer_load_dwordx4 v[84:87], v3, s[32:35], s53 offen offset:0 nt
  buffer_load_dwordx4 v[88:91], v3, s[32:35], s53 offen offset:256 nt
  buffer_load_dwordx4 v[92:95], v3, s[32:35], s53 offen offset:512 nt
  buffer_load_dwordx4 v[96:99], v3, s[32:35], s53 offen offset:768 nt
  buffer_load_dwordx4 v[100:103], v4, s[32:35], s53 offen offset:1024 nt
  s_add_u32 s53, s53, 1152
  buffer_load_dwordx4 v[104:107], v3, s[32:35], s53 offen offset:0 nt
  buffer_load_dwordx4 v[108:111], v3, s[32:35], s53 offen offset:256 nt
  buffer_load_dwordx4 v[112:115], v3, s[32:35], s53 offen offset:512 nt
  buffer_load_dwordx4 v[116:119], v3, s[32:35], s53 offen offset:768 nt
  buffer_load_dwordx4 v[120:123], v4, s[32:35], s53 offen offset:1024 nt
  s_add_u32 s53, s53, 1152
  buffer_load_dwordx4 v[124:127], v3, s[32:35], s53 offen offset:0 nt
  buffer_load_dwordx4 v[128:131], v3, s[32:35], s53 offen offset:256 nt
  buffer_load_dwordx4 v[132:135], v3, s[32:35], s53 offen offset:512 nt
  buffer_load_dwordx4 v[136:139], v3, s[32:35], s53 offen offset:768 nt
  buffer_load_dwordx4 v[140:143], v4, s[32:35], s53 offen offset:1024 nt
  s_add_u32 s53, s53, 1152
  s_waitcnt vmcnt(0)
  buffer_load_dwordx4 v[160:163], v6, s[28:31], 0 offen sc1
  buffer_load_dwordx4 v[164:167], v7, s[28:31], 0 offen sc1
  buffer_load_dwordx4 v[168:171], v7, s[28:31], 0 offen offset:64 sc1
  s_waitcnt vmcnt(0)
  v_cmp_ne_u32 vcc, s24, v161
  v_cmp_ne_u32 s[40:41], s24, v163
  s_or_b64 s[40:41], s[40:41], vcc
  v_cmp_ne_u32 vcc, s24, v165
  v_cmp_ne_u32 s[42:43], s24, v167
  s_or_b64 s[42:43], s[42:43], vcc
  v_cmp_ne_u32 vcc, s24, v169
  v_cmp_ne_u32 s[44:45], s24, v171
  s_or_b64 s[44:45], s[44:45], vcc
  s_mov_b64 s[48:49], s[40:41]
  s_or_b64 s[48:49], s[48:49], s[42:43]
  s_or_b64 s[48:49], s[48:49], s[44:45]
  s_cmp_eq_u64 s[48:49], 0
  s_cbranch_scc1 L_h1_A
  s_mov_b32 s52, 200000
L_h1slow:
  s_and_b32 s48, s40, 0xffff
  s_bcnt1_i32_b32 s48, s48
  s_cmp_le_u32 s48, 3
  s_cbranch_scc1 L_h1fast
  s_sub_u32 s52, s52, 1
  s_cbranch_scc1 L_h1fast
  s_sleep 2
  buffer_load_dwordx4 v[160:163], v6, s[28:31], 0 offen sc1
  s_waitcnt vmcnt(0)
  v_cmp_ne_u32 vcc, s24, v161
  v_cmp_ne_u32 s[40:41], s24, v163
  s_or_b64 s[40:41], s[40:41], vcc
  s_branch L_h1slow
L_h1fast:
  buffer_load_dwordx4 v[160:163], v6, s[28:31], 0 offen sc1
  buffer_load_dwordx4 v[164:167], v7, s[28:31], 0 offen sc1
  buffer_load_dwordx4 v[168:171], v7, s[28:31], 0 offen offset:64 sc1
  s_sleep 8
  buffer_load_dwordx4 v[172:175], v6, s[28:31], 0 offen sc1
  buffer_load_dwordx4 v[176:179], v7, s[28:31], 0 offen sc1
  buffer_load_dwordx4 v[180:183], v7, s[28:31], 0 offen offset:64 sc1
  s_mov_b32 s52, 200000
L_h1_loop:
  s_waitcnt vmcnt(3)
  v_cmp_ne_u32 vcc, s24, v161
  v_cmp_ne_u32 s[40:41], s24, v163
  s_or_b64 s[40:41], s[40:41], vcc
  v_cmp_ne_u32 vcc, s24, v165
  v_cmp_ne_u32 s[42:43], s24, v167
  s_or_b64 s[42:43], s[42:43], vcc
  v_cmp_ne_u32 vcc, s24, v169
  v_cmp_ne_u32 s[44:45], s24, v171
  s_or_b64 s[44:45], s[44:45], vcc
  s_mov_b64 s[48:49], s[40:41]
  s_or_b64 s[48:49], s[48:49], s[42:43]
  s_or_b64 s[48:49], s[48:49], s[44:45]
  s_cmp_eq_u64 s[48:49], 0
  s_cbranch_scc1 L_h1_A
  s_or_b32 exec_lo, s40, 1
  s_mov_b32 exec_hi, s41
  buffer_load_dwordx4 v[160:163], v6, s[28:31], 0 offen sc1
  s_or_b32 exec_lo, s42, 1
  s_mov_b32 exec_hi, s43
  buffer_load_dwordx4 v[164:167], v7, s[28:31], 0 offen sc1
  s_or_b32 exec_lo, s44, 1
  s_mov_b32 exec_hi, s45
  buffer_load_dwordx4 v[168:171], v7, s[28:31], 0 offen offset:64 sc1
  s_mov_b64 exec, -1
  s_waitcnt vmcnt(3)
  v_cmp_ne_u32 vcc, s24, v173
  v_cmp_ne_u32 s[40:41], s24, v175
  s_or_b64 s[40:41], s[40:41], vcc
  v_cmp_ne_u32 vcc, s24, v177
  v_cmp_ne_u32 s[42:43], s24, v179
  s_or_b64 s[42:43], s[42:43], vcc
  v_cmp_ne_u32 vcc, s24, v181
  v_cmp_ne_u32 s[44:45], s24, v183
  s_or_b64 s[44:45], s[44:45], vcc
  s_mov_b64 s[48:49], s[40:41]
  s_or_b64 s[48:49], s[48:49], s[42:43]
  s_or_b64 s[48:49], s[48:49], s[44:45]
  s_cmp_eq_u64 s[48:49], 0
  s_cbranch_scc1 L_h1_B
  s_or_b32 exec_lo, s40, 1
  s_mov_b32 exec_hi, s41
  buffer_load_dwordx4 v[172:175], v6, s[28:31], 0 offen sc1
  s_or_b32 exec_lo, s42, 1
  s_mov_b32 exec_hi, s43
  buffer_load_dwordx4 v[176:179], v7, s[28:31], 0 offen sc1
  s_or_b32 exec_lo, s44, 1
  s_mov_b32 exec_hi, s45
  buffer_load_dwordx4 v[180:183], v7, s[28:31], 0 offen offset:64 sc1
  s_mov_b64 exec, -1
  s_sub_u32 s52, s52, 1
  s_cbranch_scc0 L_h1_loop
L_h1_A:
  v_mov_b32 v30, v160
  v_mov_b32 v31, v162
  v_mov_b32 v33, v164
  v_mov_b32 v34, v166
  v_mov_b32 v35, v168
  v_mov_b32 v36, v170
  s_branch L_h1_done
L_h1_B:
  v_mov_b32 v30, v172
  v_mov_b32 v31, v174
  v_mov_b32 v33, v176
  v_mov_b32 v34, v178
  v_mov_b32 v35, v180
  v_mov_b32 v36, v182
L_h1_done:
  v_mov_b32 v32, v30
  s_nop 1
  v_max_f32_dpp v32, v32, v32 row_ror:8 row_mask:0xf bank_mask:0xf
  s_nop 1
  v_max_f32_dpp v32, v32, v32 row_ror:4 row_mask:0xf bank_mask:0xf
  s_nop 1
  v_max_f32_dpp v32, v32, v32 row_ror:2 row_mask:0xf bank_mask:0xf
  s_nop 1
  v_max_f32_dpp v32, v32, v32 row_ror:1 row_mask:0xf bank_mask:0xf
  v_sub_f32 v30, v30, v32
  v_mul_f32 v30, 0x3fb8aa3b, v30
  v_exp_f32 v30, v30
  s_nop 0
  v_mul_f32 v32, v30, v31
  v_mul_f32 v33, v30, v33
  v_mul_f32 v34, v30, v34
  v_mul_f32 v35, v30, v35
  v_mul_f32 v36, v30, v36
  v_add_f32_dpp v32, v32, v32 row_ror:8 row_mask:0xf bank_mask:0xf
  v_add_f32_dpp v33, v33, v33 row_ror:8 row_mask:0xf bank_mask:0xf
  v_add_f32_dpp v34, v34, v34 row_ror:8 row_mask:0xf bank_mask:0xf
  v_add_f32_dpp v35, v35, v35 row_ror:8 row_mask:0xf bank_mask:0xf
  v_add_f32_dpp v36, v36, v36 row_ror:8 row_mask:0xf bank_mask:0xf
  v_add_f32_dpp v32, v32, v32 row_ror:4 row_mask:0xf bank_mask:0xf
  v_add_f32_dpp v33, v33, v33 row_ror:4 row_mask:0xf bank_mask:0xf
  v_add_f32_dpp v34, v34, v34 row_ror:4 row_mask:0xf bank_mask:0xf
  v_add_f32_dpp v35, v35, v35 row_ror:4 row_mask:0xf bank_mask:0xf
  v_add_f32_dpp v36, v36, v36 row_ror:4 row_mask:0xf bank_mask:0xf
  v_add_f32_dpp v32, v32, v32 row_ror:2 row_mask:0xf bank_mask:0xf
  v_add_f32_dpp v33, v33, v33 row_ror:2 row_mask:0xf bank_mask:0xf
  v_add_f32_dpp v34, v34, v34 row_ror:2 row_mask:0xf bank_mask:0xf
  v_add_f32_dpp v35, v35, v35 row_ror:2 row_mask:0xf bank_mask:0xf
  v_add_f32_dpp v36, v36, v36 row_ror:2 row_mask:0xf bank_mask:0xf
  v_add_f32_dpp v32, v32, v32 row_ror:1 row_mask:0xf bank_mask:0xf
  v_add_f32_dpp v33, v33, v33 row_ror:1 row_mask:0xf bank_mask:0xf
  v_add_f32_dpp v34, v34, v34 row_ror:1 row_mask:0xf bank_mask:0xf
  v_add_f32_dpp v35, v35, v35 row_ror:1 row_mask:0xf bank_mask:0xf
  v_add_f32_dpp v36, v36, v36 row_ror:1 row_mask:0xf bank_mask:0xf
  v_rcp_f32 v37, v32
  s_nop 0
  v_fma_f32 v31, -v32, v37, 1.0
  v_fma_f32 v37, v31, v37, v37
  v_mul_f32 v33, v33, v37
  v_mul_f32 v34, v34, v37
  v_mul_f32 v35, v35, v37
  v_mul_f32 v36, v36, v37
  v_cvt_pk_bf16_f32 v44, v33, v34
  v_cvt_pk_bf16_f32 v45, v35, v36
  v_perm_b32 v48, v44, v44, v16
  v_perm_b32 v49, v44, v44, v17
  v_perm_b32 v50, v44, v44, v18
  v_perm_b32 v51, v44, v44, v19
  v_perm_b32 v52, v44, v44, v20
  v_perm_b32 v53, v44, v44, v21
  v_perm_b32 v54, v44, v44, v22
  v_perm_b32 v55, v44, v44, v23
  v_perm_b32 v56, v45, v45, v16
  v_perm_b32 v57, v45, v45, v17
  v_perm_b32 v58, v45, v45, v18
  v_perm_b32 v59, v45, v45, v19
  v_perm_b32 v60, v45, v45, v20
  v_perm_b32 v61, v45, v45, v21
  v_perm_b32 v62, v45, v45, v22
  v_perm_b32 v63, v45, v45, v23
  v_mov_b32 v225, s24
  v_mov_b32 v227, s24
  v_mov_b32 v229, s24
  v_mov_b32 v231, s24
  v_mov_b32 v233, s24
  v_mov_b32 v235, s24
  v_mfma_f32_16x16x32_bf16 v[200:203], v[48:51], v[64:67], v[200:203]
  v_mfma_f32_16x16x32_bf16 v[200:203], v[52:55], v[84:87], v[200:203]
  v_mfma_f32_16x16x32_bf16 v[200:203], v[56:59], v[104:107], v[200:203]
  v_mfma_f32_16x16x32_bf16 v[200:203], v[60:63], v[124:127], v[200:203]
  v_mfma_f32_16x16x32_bf16 v[204:207], v[48:51], v[68:71], v[204:207]
  v_mfma_f32_16x16x32_bf16 v[204:207], v[52:55], v[88:91], v[204:207]
  v_mfma_f32_16x16x32_bf16 v[204:207], v[56:59], v[108:111], v[204:207]
  v_mfma_f32_16x16x32_bf16 v[204:207], v[60:63], v[128:131], v[204:207]
  v_mfma_f32_16x16x32_bf16 v[208:211], v[48:51], v[72:75], v[208:211]
  v_mfma_f32_16x16x32_bf16 v[208:211], v[52:55], v[92:95], v[208:211]
  v_mfma_f32_16x16x32_bf16 v[208:211], v[56:59], v[112:115], v[208:211]
  v_mfma_f32_16x16x32_bf16 v[208:211], v[60:63], v[132:135], v[208:211]
  v_permlane32_swap_b32 v200, v202
  v_permlane32_swap_b32 v201, v203
  s_nop 0
  v_mov_b32 v224, v200
  v_mov_b32 v226, v201
  buffer_store_dwordx4 v[224:227], v8, s[28:31], 0 offen offset:0 sc1
  v_mfma_f32_16x16x32_bf16 v[212:215], v[48:51], v[76:79], v[212:215]
  v_mfma_f32_16x16x32_bf16 v[212:215], v[52:55], v[96:99], v[212:215]
  v_mfma_f32_16x16x32_bf16 v[212:215], v[56:59], v[116:119], v[212:215]
  v_mfma_f32_16x16x32_bf16 v[212:215], v[60:63], v[136:139], v[212:215]
  v_permlane32_swap_b32 v204, v206
  v_permlane32_swap_b32 v205, v207
  s_nop 0
  v_mov_b32 v228, v204
  v_mov_b32 v230, v205
  buffer_store_dwordx4 v[228:231], v8, s[28:31], 0 offen offset:1024 sc1
  v_mfma_f32_16x16x32_bf16 v[216:219], v[48:51], v[80:83], v[216:219]
  v_mfma_f32_16x16x32_bf16 v[216:219], v[52:55], v[100:103], v[216:219]
  v_mfma_f32_16x16x32_bf16 v[216:219], v[56:59], v[120:123], v[216:219]
  v_mfma_f32_16x16x32_bf16 v[216:219], v[60:63], v[140:143], v[216:219]
  v_permlane32_swap_b32 v208, v210
  v_permlane32_swap_b32 v209, v211
  s_nop 0
  v_mov_b32 v232, v208
  v_mov_b32 v234, v209
  buffer_store_dwordx4 v[232:235], v8, s[28:31], 0 offen offset:2048 sc1
  s_nop 3
  v_permlane32_swap_b32 v212, v214
  v_permlane32_swap_b32 v213, v215
  s_nop 0
  v_mov_b32 v224, v212
  v_mov_b32 v226, v213
  buffer_store_dwordx4 v[224:227], v8, s[28:31], 0 offen offset:3072 sc1
  s_nop 3
  v_permlane32_swap_b32 v216, v218
  v_permlane32_swap_b32 v217, v219
  s_nop 0
  v_mov_b32 v228, v216
  v_mov_b32 v230, v217
  s_mov_b32 exec_lo, 0x00ff00ff
  s_mov_b32 exec_hi, 0x00ff00ff
  s_movk_i32 s41, 0x1000
  buffer_store_dwordx4 v[228:231], v8, s[28:31], s41 offen sc1
  s_mov_b64 exec, -1
  s_waitcnt vmcnt(0)
  s_cmp_lt_u32 s2, 184
  s_cbranch_scc1 L_w4end
  s_barrier
  v_and_b32 v24, 3, v0
  v_lshlrev_b32 v24, 3, v24
  v_add_u32 v24, 137984, v24
  v_lshlrev_b32 v47, 16, v14
  v_and_b32 v48, 0xffff0000, v14
  s_barrier
  ds_read_b64 v[52:53], v24 offset:0
  ds_read_b64 v[54:55], v24 offset:32
  ds_read_b64 v[56:57], v24 offset:64
  ds_read_b64 v[58:59], v24 offset:96
  s_waitcnt lgkmcnt(0)
  v_add_f32 v44, v52, v54
  v_add_f32 v45, v53, v55
  v_add_f32 v44, v44, v56
  v_add_f32 v45, v45, v57
  v_add_f32 v44, v44, v58
  v_add_f32 v45, v45, v59
  v_add_f32 v44, v47, v44
  v_add_f32 v45, v48, v45
  v_cvt_pk_bf16_f32 v46, v44, v45
  s_mov_b64 exec, 0xf
  buffer_store_dword v46, v9, s[36:39], 0 offen
  s_cmp_eq_u32 s50, 0
  s_cbranch_scc0 L_noE
  s_mov_b64 exec, 1
  v_mov_b32 v47, s24
  v_mov_b32 v48, 0
  buffer_store_dword v47, v48, s[28:31], 0 offen sc1
L_noE:
  s_mov_b64 exec, -1
L_w4end:
  s_endpgm
L_end:
  s_endpgm
L_codeend:
.section .rodata,"a"
.p2align 6
.amdhsa_kernel parallel_sum__gqa_block_cached__dense_activation_silu__decode_kernel
  .amdhsa_next_free_vgpr 256
  .amdhsa_next_free_sgpr 102
  .amdhsa_accum_offset 256
  .amdhsa_group_segment_fixed_size 0
  .amdhsa_kernarg_size 88
  .amdhsa_user_sgpr_count 2
  .amdhsa_user_sgpr_kernarg_segment_ptr 1
  .amdhsa_system_sgpr_workgroup_id_x 1
  .amdhsa_float_denorm_mode_32 3
  .amdhsa_float_denorm_mode_16_64 3
.end_amdhsa_kernel
```
